```python
import torch

def _softmax(x, axis=-1):
    return torch.softmax(x, dim=axis)
def _gelu(x):
    return torch.nn.functional.gelu(x, approximate="tanh")
def _silu(x):
    return torch.nn.functional.silu(x)
def _sigmoid(x):
    return torch.sigmoid(x)
def _layernorm(x, axis=-1, eps=1e-5):
    m = x.mean(dim=axis, keepdim=True)
    v = x.var(dim=axis, keepdim=True, unbiased=False)
    return (x - m) / torch.sqrt(v + eps)
def _scatter_add(tgt, idx, src, axis=0):
    return tgt.clone().index_add_(axis, idx, src)
def _segment_sum(src, seg, n):
    out = torch.zeros((n,) + src.shape[1:], dtype=src.dtype)
    return out.index_add_(0, seg, src)
def _pad(x, pw):
    flat = tuple(v for pair in reversed(pw) for v in pair)
    return torch.nn.functional.pad(x, flat)

kernel_name = 'gather_scatter__edge_featured_mpnn_gatedgcn__graph'

def setup_inputs():

    _w = (lambda a: (lambda t: t.to(torch.bfloat16) if t.is_floating_point() else t)(torch.as_tensor(a)))
    N, deg, D, De = 50000, 16, 64, max(16, 1)
    E = N * deg
    return {
        "x": _w((lambda *s: torch.randn(*s, dtype=torch.bfloat16) * 0.4)(N, D)),
        "e_attr": _w((lambda *s: torch.randn(*s, dtype=torch.bfloat16) * 0.8)(E, De)),
        "src": _w((lambda lo, hi, *s: torch.randint(lo, hi, s))(0, N, E).to(torch.int64)),
        "dst": _w((lambda lo, hi, *s: torch.randint(lo, hi, s))(0, N, E).to(torch.int64)),
        "w_a": _w((lambda *s: torch.randn(*s, dtype=torch.bfloat16) * 0.8)(D, D)),
        "w_b": _w((lambda *s: torch.randn(*s, dtype=torch.bfloat16) * 0.4)(D, D)),
        "w_c": _w((lambda *s: torch.randn(*s, dtype=torch.bfloat16) * 0.8)(De, D)),
        "w_u": _w((lambda *s: torch.randn(*s, dtype=torch.bfloat16) * 0.05)(D, D)),
        "w_v": _w((lambda *s: torch.randn(*s, dtype=torch.bfloat16) * 0.05)(D, D)),
    }

def reference(x, e_attr, src, dst, w_a, w_b, w_c, w_u, w_v):
    N, D = x.shape
    hv = x @ w_v
    g = x[dst] @ w_a + x[src] @ w_b + e_attr @ w_c
    eta = _sigmoid(g)
    denom = _segment_sum(eta, dst, N) + 1e-6
    eta_n = eta / denom[dst]
    agg = _segment_sum(eta_n * hv[src], dst, N)
    z = x @ w_u + agg
    relu_z = torch.where(z > 0, z, 0 * z)
    return x + relu_z
```

```asm
; @launch kernel=gp_part_kernel grid=(255,1,1) block=(640,1,1) lds=27648
; @launch kernel=gp_main_kernel grid=(256,1,1) block=(512,1,1) lds=159360
.amdgcn_target "amdgcn-amd-amdhsa--gfx950"
.text
.globl gp_part_kernel
.p2align 8
.type gp_part_kernel,@function
gp_part_kernel:
    s_cmp_gt_u32 s2, 254
    s_cbranch_scc1 P_END
    s_load_dwordx4 s[4:7], s[0:1], 16
    s_load_dwordx2 s[8:9], s[0:1], 88
    s_cmp_ge_u32 s2, 250
    s_cbranch_scc1 P_WEIGHTS
    v_lshlrev_b32 v1, 2, v0
    v_mov_b32 v2, 0
    v_mov_b32 v4, 1
    v_cmp_gt_u32 vcc, 256, v0
    s_and_saveexec_b64 s[30:31], vcc
    ds_write_b32 v1, v2
    s_mov_b64 exec, s[30:31]
    s_waitcnt lgkmcnt(0)
    s_mov_b32 s12, s4
    s_and_b32 s13, s5, 0xffff
    s_mov_b32 s14, 3200000
    s_mov_b32 s15, 0x00020000
    s_mov_b32 s16, s6
    s_and_b32 s17, s7, 0xffff
    s_mov_b32 s18, 3200000
    s_mov_b32 s19, 0x00020000
    s_mov_b32 s20, s8
    s_and_b32 s21, s9, 0xffff
    s_mov_b32 s22, 8388608
    s_mov_b32 s23, 0x00020000
    s_mul_i32 s3, s2, 12800
    v_add_u32 v3, s3, v1
    s_mov_b32 s40, 5120
    s_mov_b32 s41, 10240
    buffer_load_dword v10, v3, s[16:19], 0 offen
    buffer_load_dword v11, v3, s[16:19], 0 offen offset:2560
    buffer_load_dword v12, v3, s[16:19], s40 offen
    buffer_load_dword v13, v3, s[16:19], s40 offen offset:2560
    buffer_load_dword v14, v3, s[16:19], s41 offen
    buffer_load_dword v15, v3, s[12:15], 0 offen
    buffer_load_dword v16, v3, s[12:15], 0 offen offset:2560
    buffer_load_dword v17, v3, s[12:15], s40 offen
    buffer_load_dword v18, v3, s[12:15], s40 offen offset:2560
    buffer_load_dword v19, v3, s[12:15], s41 offen
    s_mov_b32 s42, 21913099
    v_lshlrev_b32 v9, 3, v3
    s_barrier
    s_waitcnt vmcnt(5)
    v_mul_hi_u32 v5, v10, s42
    v_mul_u32_u24 v6, 196, v5
    v_sub_u32 v6, v10, v6
    v_lshlrev_b32 v20, 2, v5
    ds_add_rtn_u32 v25, v20, v4
    v_lshl_add_u32 v7, v6, 1, 1
    v_mul_u32_u24 v7, 1338, v7
    v_lshrrev_b32 v7, 16, v7
    v_mul_u32_u24 v8, 49, v7
    v_lshrrev_b32 v8, 1, v8
    v_sub_u32 v8, v6, v8
    v_lshlrev_b32 v10, 16, v7
    v_add_u32 v31, 0, v9
    v_or_b32 v31, v31, v8
    v_mul_hi_u32 v5, v11, s42
    v_mul_u32_u24 v6, 196, v5
    v_sub_u32 v6, v11, v6
    v_lshlrev_b32 v21, 2, v5
    ds_add_rtn_u32 v26, v21, v4
    v_lshl_add_u32 v7, v6, 1, 1
    v_mul_u32_u24 v7, 1338, v7
    v_lshrrev_b32 v7, 16, v7
    v_mul_u32_u24 v8, 49, v7
    v_lshrrev_b32 v8, 1, v8
    v_sub_u32 v8, v6, v8
    v_lshlrev_b32 v11, 16, v7
    v_add_u32 v33, 20480, v9
    v_or_b32 v33, v33, v8
    v_mul_hi_u32 v5, v12, s42
    v_mul_u32_u24 v6, 196, v5
    v_sub_u32 v6, v12, v6
    v_lshlrev_b32 v22, 2, v5
    ds_add_rtn_u32 v27, v22, v4
    v_lshl_add_u32 v7, v6, 1, 1
    v_mul_u32_u24 v7, 1338, v7
    v_lshrrev_b32 v7, 16, v7
    v_mul_u32_u24 v8, 49, v7
    v_lshrrev_b32 v8, 1, v8
    v_sub_u32 v8, v6, v8
    v_lshlrev_b32 v12, 16, v7
    v_add_u32 v35, 40960, v9
    v_or_b32 v35, v35, v8
    v_mul_hi_u32 v5, v13, s42
    v_mul_u32_u24 v6, 196, v5
    v_sub_u32 v6, v13, v6
    v_lshlrev_b32 v23, 2, v5
    ds_add_rtn_u32 v28, v23, v4
    v_lshl_add_u32 v7, v6, 1, 1
    v_mul_u32_u24 v7, 1338, v7
    v_lshrrev_b32 v7, 16, v7
    v_mul_u32_u24 v8, 49, v7
    v_lshrrev_b32 v8, 1, v8
    v_sub_u32 v8, v6, v8
    v_lshlrev_b32 v13, 16, v7
    v_add_u32 v37, 61440, v9
    v_or_b32 v37, v37, v8
    v_mul_hi_u32 v5, v14, s42
    v_mul_u32_u24 v6, 196, v5
    v_sub_u32 v6, v14, v6
    v_lshlrev_b32 v24, 2, v5
    ds_add_rtn_u32 v29, v24, v4
    v_lshl_add_u32 v7, v6, 1, 1
    v_mul_u32_u24 v7, 1338, v7
    v_lshrrev_b32 v7, 16, v7
    v_mul_u32_u24 v8, 49, v7
    v_lshrrev_b32 v8, 1, v8
    v_sub_u32 v8, v6, v8
    v_lshlrev_b32 v14, 16, v7
    v_add_u32 v39, 81920, v9
    v_or_b32 v39, v39, v8
    s_waitcnt vmcnt(0)
    v_or_b32 v30, v10, v15
    v_or_b32 v32, v11, v16
    v_or_b32 v34, v12, v17
    v_or_b32 v36, v13, v18
    v_or_b32 v38, v14, v19
    s_waitcnt lgkmcnt(0)
    s_barrier
    v_cmp_gt_u32 vcc, 64, v0
    s_and_saveexec_b64 s[30:31], vcc
    s_cbranch_execz P_SCAN_DONE
    v_lshlrev_b32 v40, 4, v0
    ds_read_b128 v[44:47], v40
    s_waitcnt lgkmcnt(0)
    v_add_u32 v48, v44, v45
    v_add_u32 v49, v48, v46
    v_add_u32 v50, v49, v47
    v_mov_b32 v51, v50
    s_nop 1
    v_add_u32_dpp v51, v51, v51 row_shr:1 row_mask:0xf bank_mask:0xf bound_ctrl:0
    s_nop 1
    v_add_u32_dpp v51, v51, v51 row_shr:2 row_mask:0xf bank_mask:0xf bound_ctrl:0
    s_nop 1
    v_add_u32_dpp v51, v51, v51 row_shr:4 row_mask:0xf bank_mask:0xf bound_ctrl:0
    s_nop 1
    v_add_u32_dpp v51, v51, v51 row_shr:8 row_mask:0xf bank_mask:0xf bound_ctrl:0
    s_nop 1
    v_add_u32_dpp v51, v51, v51 row_bcast:15 row_mask:0xa bank_mask:0xf
    s_nop 1
    v_add_u32_dpp v51, v51, v51 row_bcast:31 row_mask:0xc bank_mask:0xf
    v_sub_u32 v52, v51, v50
    v_add_u32 v53, v52, v44
    v_add_u32 v54, v52, v48
    v_add_u32 v55, v52, v49
    ds_write_b128 v40, v[52:55] offset:1024
    s_lshl_b32 s43, s2, 2
    s_add_u32 s43, s43, 6400000
    v_lshlrev_b32 v41, 12, v0
    buffer_store_dword v52, v41, s[20:23], s43 offen
    buffer_store_dword v53, v41, s[20:23], s43 offen offset:1024
    buffer_store_dword v54, v41, s[20:23], s43 offen offset:2048
    buffer_store_dword v55, v41, s[20:23], s43 offen offset:3072
    v_cmp_eq_u32 vcc, 63, v0
    s_and_b64 exec, exec, vcc
    s_add_u32 s43, s43, 4096
    buffer_store_dword v51, v41, s[20:23], s43 offen
    s_waitcnt lgkmcnt(0)
P_SCAN_DONE:
    s_mov_b64 exec, s[30:31]
    s_barrier
    ds_read_b32 v44, v20 offset:1024
    ds_read_b32 v45, v21 offset:1024
    ds_read_b32 v46, v22 offset:1024
    ds_read_b32 v47, v23 offset:1024
    ds_read_b32 v48, v24 offset:1024
    s_waitcnt lgkmcnt(0)
    v_add_u32 v5, v44, v25
    v_lshlrev_b32 v5, 3, v5
    ds_write_b64 v5, v[30:31] offset:2048
    v_add_u32 v5, v45, v26
    v_lshlrev_b32 v5, 3, v5
    ds_write_b64 v5, v[32:33] offset:2048
    v_add_u32 v5, v46, v27
    v_lshlrev_b32 v5, 3, v5
    ds_write_b64 v5, v[34:35] offset:2048
    v_add_u32 v5, v47, v28
    v_lshlrev_b32 v5, 3, v5
    ds_write_b64 v5, v[36:37] offset:2048
    v_add_u32 v5, v48, v29
    v_lshlrev_b32 v5, 3, v5
    ds_write_b64 v5, v[38:39] offset:2048
    s_waitcnt lgkmcnt(0)
    s_barrier
    v_lshlrev_b32 v5, 4, v0
    s_mul_i32 s44, s2, 25600
    ds_read_b128 v[44:47], v5 offset:2048
    ds_read_b128 v[48:51], v5 offset:12288
    v_cmp_gt_u32 vcc, 320, v0
    s_and_saveexec_b64 s[30:31], vcc
    ds_read_b128 v[52:55], v5 offset:22528
    s_mov_b64 exec, s[30:31]
    s_add_u32 s45, s44, 10240
    s_add_u32 s46, s44, 20480
    s_waitcnt lgkmcnt(2)
    buffer_store_dwordx4 v[44:47], v5, s[20:23], s44 offen
    s_waitcnt lgkmcnt(1)
    buffer_store_dwordx4 v[48:51], v5, s[20:23], s45 offen
    s_waitcnt lgkmcnt(0)
    s_and_saveexec_b64 s[30:31], vcc
    buffer_store_dwordx4 v[52:55], v5, s[20:23], s46 offen
    s_endpgm
P_WEIGHTS:
    s_sub_u32 s3, s2, 250
    s_lshl_b32 s40, s3, 13
    s_add_u32 s40, s40, 6668288
    s_mov_b32 s41, 32
    s_cmp_eq_u32 s3, 1
    s_cselect_b32 s41, 40, s41
    s_cmp_eq_u32 s3, 2
    s_cselect_b32 s41, 64, s41
    s_cmp_eq_u32 s3, 3
    s_cselect_b32 s41, 56, s41
    s_cmp_eq_u32 s3, 4
    s_cselect_b32 s41, 48, s41
    s_movk_i32 s42, 0x2000
    s_cselect_b32 s42, 2048, s42
    s_load_dwordx2 s[12:13], s[0:1], s41
    s_waitcnt lgkmcnt(0)
    s_mov_b32 s20, s8
    s_and_b32 s21, s9, 0xffff
    s_mov_b32 s22, 8388608
    s_mov_b32 s23, 0x00020000
    s_mov_b32 s28, s12
    s_and_b32 s29, s13, 0xffff
    s_mov_b32 s30, 0
    s_mov_b32 s31, 0x00020000
    s_mov_b32 s30, s42
    v_add_u32 v1, 0, v0
    v_lshlrev_b32 v2, 1, v1
    buffer_load_ushort v10, v2, s[28:31], 0 offen
    v_lshrrev_b32 v3, 10, v1
    v_bfe_u32 v4, v1, 5, 1
    v_lshl_add_u32 v3, v3, 1, v4
    v_bfe_u32 v4, v1, 9, 1
    v_lshl_add_u32 v3, v3, 1, v4
    v_and_b32 v4, 31, v1
    v_lshl_add_u32 v3, v3, 5, v4
    v_bfe_u32 v4, v1, 6, 3
    v_lshl_add_u32 v3, v3, 3, v4
    v_lshlrev_b32 v3, 1, v3
    v_mov_b32 v5, 0x40000000
    v_cmp_gt_u32 vcc, s42, v2
    s_nop 1
    v_cndmask_b32 v20, v5, v3, vcc
    v_add_u32 v1, 640, v0
    v_lshlrev_b32 v2, 1, v1
    buffer_load_ushort v11, v2, s[28:31], 0 offen
    v_lshrrev_b32 v3, 10, v1
    v_bfe_u32 v4, v1, 5, 1
    v_lshl_add_u32 v3, v3, 1, v4
    v_bfe_u32 v4, v1, 9, 1
    v_lshl_add_u32 v3, v3, 1, v4
    v_and_b32 v4, 31, v1
    v_lshl_add_u32 v3, v3, 5, v4
    v_bfe_u32 v4, v1, 6, 3
    v_lshl_add_u32 v3, v3, 3, v4
    v_lshlrev_b32 v3, 1, v3
    v_mov_b32 v5, 0x40000000
    v_cmp_gt_u32 vcc, s42, v2
    s_nop 1
    v_cndmask_b32 v21, v5, v3, vcc
    v_add_u32 v1, 1280, v0
    v_lshlrev_b32 v2, 1, v1
    buffer_load_ushort v12, v2, s[28:31], 0 offen
    v_lshrrev_b32 v3, 10, v1
    v_bfe_u32 v4, v1, 5, 1
    v_lshl_add_u32 v3, v3, 1, v4
    v_bfe_u32 v4, v1, 9, 1
    v_lshl_add_u32 v3, v3, 1, v4
    v_and_b32 v4, 31, v1
    v_lshl_add_u32 v3, v3, 5, v4
    v_bfe_u32 v4, v1, 6, 3
    v_lshl_add_u32 v3, v3, 3, v4
    v_lshlrev_b32 v3, 1, v3
    v_mov_b32 v5, 0x40000000
    v_cmp_gt_u32 vcc, s42, v2
    s_nop 1
    v_cndmask_b32 v22, v5, v3, vcc
    v_add_u32 v1, 1920, v0
    v_lshlrev_b32 v2, 1, v1
    buffer_load_ushort v13, v2, s[28:31], 0 offen
    v_lshrrev_b32 v3, 10, v1
    v_bfe_u32 v4, v1, 5, 1
    v_lshl_add_u32 v3, v3, 1, v4
    v_bfe_u32 v4, v1, 9, 1
    v_lshl_add_u32 v3, v3, 1, v4
    v_and_b32 v4, 31, v1
    v_lshl_add_u32 v3, v3, 5, v4
    v_bfe_u32 v4, v1, 6, 3
    v_lshl_add_u32 v3, v3, 3, v4
    v_lshlrev_b32 v3, 1, v3
    v_mov_b32 v5, 0x40000000
    v_cmp_gt_u32 vcc, s42, v2
    s_nop 1
    v_cndmask_b32 v23, v5, v3, vcc
    v_add_u32 v1, 2560, v0
    v_lshlrev_b32 v2, 1, v1
    buffer_load_ushort v14, v2, s[28:31], 0 offen
    v_lshrrev_b32 v3, 10, v1
    v_bfe_u32 v4, v1, 5, 1
    v_lshl_add_u32 v3, v3, 1, v4
    v_bfe_u32 v4, v1, 9, 1
    v_lshl_add_u32 v3, v3, 1, v4
    v_and_b32 v4, 31, v1
    v_lshl_add_u32 v3, v3, 5, v4
    v_bfe_u32 v4, v1, 6, 3
    v_lshl_add_u32 v3, v3, 3, v4
    v_lshlrev_b32 v3, 1, v3
    v_mov_b32 v5, 0x40000000
    v_cmp_gt_u32 vcc, s42, v2
    s_nop 1
    v_cndmask_b32 v24, v5, v3, vcc
    v_add_u32 v1, 3200, v0
    v_lshlrev_b32 v2, 1, v1
    buffer_load_ushort v15, v2, s[28:31], 0 offen
    v_lshrrev_b32 v3, 10, v1
    v_bfe_u32 v4, v1, 5, 1
    v_lshl_add_u32 v3, v3, 1, v4
    v_bfe_u32 v4, v1, 9, 1
    v_lshl_add_u32 v3, v3, 1, v4
    v_and_b32 v4, 31, v1
    v_lshl_add_u32 v3, v3, 5, v4
    v_bfe_u32 v4, v1, 6, 3
    v_lshl_add_u32 v3, v3, 3, v4
    v_lshlrev_b32 v3, 1, v3
    v_mov_b32 v5, 0x40000000
    v_cmp_gt_u32 vcc, s42, v2
    s_nop 1
    v_cndmask_b32 v25, v5, v3, vcc
    v_add_u32 v1, 3840, v0
    v_lshlrev_b32 v2, 1, v1
    buffer_load_ushort v16, v2, s[28:31], 0 offen
    v_lshrrev_b32 v3, 10, v1
    v_bfe_u32 v4, v1, 5, 1
    v_lshl_add_u32 v3, v3, 1, v4
    v_bfe_u32 v4, v1, 9, 1
    v_lshl_add_u32 v3, v3, 1, v4
    v_and_b32 v4, 31, v1
    v_lshl_add_u32 v3, v3, 5, v4
    v_bfe_u32 v4, v1, 6, 3
    v_lshl_add_u32 v3, v3, 3, v4
    v_lshlrev_b32 v3, 1, v3
    v_mov_b32 v5, 0x40000000
    v_cmp_gt_u32 vcc, s42, v2
    s_nop 1
    v_cndmask_b32 v26, v5, v3, vcc
    s_waitcnt vmcnt(0)
    s_mov_b32 s44, 1.0
    s_cmp_eq_u32 s3, 1
    s_cselect_b32 s44, 0xbfb8aa3b, s44
    s_cmp_eq_u32 s3, 4
    s_cselect_b32 s44, 0xbfb8aa3b, s44
    v_lshlrev_b32 v10, 16, v10
    v_mul_f32 v10, s44, v10
    v_cvt_pk_bf16_f32 v10, v10, v10
    v_lshlrev_b32 v11, 16, v11
    v_mul_f32 v11, s44, v11
    v_cvt_pk_bf16_f32 v11, v11, v11
    v_lshlrev_b32 v12, 16, v12
    v_mul_f32 v12, s44, v12
    v_cvt_pk_bf16_f32 v12, v12, v12
    v_lshlrev_b32 v13, 16, v13
    v_mul_f32 v13, s44, v13
    v_cvt_pk_bf16_f32 v13, v13, v13
    v_lshlrev_b32 v14, 16, v14
    v_mul_f32 v14, s44, v14
    v_cvt_pk_bf16_f32 v14, v14, v14
    v_lshlrev_b32 v15, 16, v15
    v_mul_f32 v15, s44, v15
    v_cvt_pk_bf16_f32 v15, v15, v15
    v_lshlrev_b32 v16, 16, v16
    v_mul_f32 v16, s44, v16
    v_cvt_pk_bf16_f32 v16, v16, v16
    buffer_store_short v10, v20, s[20:23], s40 offen
    buffer_store_short v11, v21, s[20:23], s40 offen
    buffer_store_short v12, v22, s[20:23], s40 offen
    buffer_store_short v13, v23, s[20:23], s40 offen
    buffer_store_short v14, v24, s[20:23], s40 offen
    buffer_store_short v15, v25, s[20:23], s40 offen
    buffer_store_short v16, v26, s[20:23], s40 offen
P_END:
    s_endpgm
.globl gp_main_kernel
.p2align 8
.type gp_main_kernel,@function
gp_main_kernel:
    s_cmp_ge_u32 s2, 256
    s_cbranch_scc1 M_END
    s_and_b32 s3, s2, 7
    s_lshl_b32 s3, s3, 5
    s_lshr_b32 s2, s2, 3
    s_add_u32 s2, s2, s3
    s_load_dwordx2 s[10:11], s[0:1], 88
    s_load_dwordx4 s[4:7], s[0:1], 0
    s_load_dwordx2 s[8:9], s[0:1], 72
    v_and_b32 v160, 63, v0
    v_lshrrev_b32 v2, 6, v0
    s_nop 0
    v_readfirstlane_b32 s28, v2
    v_lshlrev_b32 v164, 4, v160
    v_lshrrev_b32 v161, 4, v160
    v_lshrrev_b32 v165, 3, v160
    s_mov_b32 s29, 0
    s_mov_b32 s34, 0
    s_mov_b32 s35, 32
    s_lshl_b32 s36, s28, 13
    s_mul_i32 s42, s2, 196
    s_mul_i32 s43, s28, 49
    s_lshr_b32 s43, s43, 1
    s_add_u32 s42, s42, s43
    s_lshl_b32 s46, s42, 7
    v_and_b32 v4, 7, v160
    v_and_b32 v5, 1, v161
    v_lshlrev_b32 v5, 2, v5
    v_xor_b32 v5, v4, v5
    v_lshlrev_b32 v14, 4, v5
    v_xor_b32 v15, 16, v14
    v_xor_b32 v1, 32, v14
    v_xor_b32 v31, 48, v14
    s_waitcnt lgkmcnt(0)
    s_mov_b32 s24, s10
    s_and_b32 s25, s11, 0xffff
    s_mov_b32 s26, 8388608
    s_mov_b32 s27, 0x00020000
    s_mov_b32 s12, s4
    s_and_b32 s13, s5, 0xffff
    s_mov_b32 s14, 6400000
    s_mov_b32 s15, 0x00020000
M_ROUND:
    v_lshrrev_b32 v2, 3, v0
    v_lshlrev_b32 v3, 2, v2
    s_lshl_b32 s38, s2, 10
    s_add_u32 s38, s38, 6400000
    buffer_load_dword v36, v3, s[24:27], s38 offen
    buffer_load_dword v32, v3, s[24:27], s38 offen offset:1024
    buffer_load_dword v37, v3, s[24:27], s38 offen offset:256
    buffer_load_dword v33, v3, s[24:27], s38 offen offset:1280
    buffer_load_dword v38, v3, s[24:27], s38 offen offset:512
    buffer_load_dword v34, v3, s[24:27], s38 offen offset:1536
    buffer_load_dword v39, v3, s[24:27], s38 offen offset:768
    buffer_load_dword v35, v3, s[24:27], s38 offen offset:1792
    v_lshrrev_b32 v2, 3, v0
    v_and_b32 v4, 7, v0
    v_lshlrev_b32 v4, 1, v4
    v_add_u32 v8, s34, v4
    s_waitcnt vmcnt(0)
    v_sub_u32 v32, v32, v36
    v_subrev_u32 v32, s34, v32
    v_mov_b32 v7, v32
    v_min_i32 v32, s35, v32
    v_sub_u32 v32, v32, v4
    v_add_u32 v5, 0, v2
    v_mul_u32_u24 v5, 3200, v5
    v_add3_u32 v5, v5, v36, v8
    v_lshlrev_b32 v36, 3, v5
    v_sub_u32 v33, v33, v37
    v_subrev_u32 v33, s34, v33
    v_max_i32 v7, v7, v33
    v_min_i32 v33, s35, v33
    v_sub_u32 v33, v33, v4
    v_add_u32 v5, 64, v2
    v_mul_u32_u24 v5, 3200, v5
    v_add3_u32 v5, v5, v37, v8
    v_lshlrev_b32 v37, 3, v5
    v_sub_u32 v34, v34, v38
    v_subrev_u32 v34, s34, v34
    v_max_i32 v7, v7, v34
    v_min_i32 v34, s35, v34
    v_sub_u32 v34, v34, v4
    v_add_u32 v5, 128, v2
    v_mul_u32_u24 v5, 3200, v5
    v_add3_u32 v5, v5, v38, v8
    v_lshlrev_b32 v38, 3, v5
    v_sub_u32 v35, v35, v39
    v_cmp_gt_u32 vcc, 58, v2
    s_nop 1
    v_cndmask_b32 v35, 0, v35, vcc
    v_subrev_u32 v35, s34, v35
    v_max_i32 v7, v7, v35
    v_min_i32 v35, s35, v35
    v_sub_u32 v35, v35, v4
    v_add_u32 v5, 192, v2
    v_mul_u32_u24 v5, 3200, v5
    v_add3_u32 v5, v5, v39, v8
    v_lshlrev_b32 v39, 3, v5
    v_cmp_lt_i32 s[40:41], s35, v7
    v_cmp_lt_i32 s[66:67], 0, v32
    v_cmp_lt_i32 s[68:69], 1, v32
    v_cmp_lt_i32 s[70:71], 16, v32
    v_cmp_lt_i32 s[72:73], 17, v32
    v_cmp_lt_i32 s[74:75], 0, v33
    v_cmp_lt_i32 s[76:77], 1, v33
    v_cmp_lt_i32 s[78:79], 16, v33
    v_cmp_lt_i32 s[80:81], 17, v33
    v_cmp_lt_i32 s[82:83], 0, v34
    v_cmp_lt_i32 s[84:85], 1, v34
    v_cmp_lt_i32 s[86:87], 16, v34
    v_cmp_lt_i32 s[88:89], 17, v34
    v_cmp_lt_i32 s[90:91], 0, v35
    v_cmp_lt_i32 s[92:93], 1, v35
    v_cmp_lt_i32 s[94:95], 16, v35
    v_cmp_lt_i32 s[96:97], 17, v35
    s_mov_b64 exec, s[66:67]
    s_cbranch_execz M_LD_00
    buffer_load_dwordx4 v[40:43], v36, s[24:27], 0 offen
M_LD_00:
    s_mov_b64 exec, s[70:71]
    s_cbranch_execz M_LD_01
    buffer_load_dwordx4 v[44:47], v36, s[24:27], 0 offen offset:128
M_LD_01:
    s_mov_b64 exec, s[74:75]
    s_cbranch_execz M_LD_10
    buffer_load_dwordx4 v[48:51], v37, s[24:27], 0 offen
M_LD_10:
    s_mov_b64 exec, s[78:79]
    s_cbranch_execz M_LD_11
    buffer_load_dwordx4 v[52:55], v37, s[24:27], 0 offen offset:128
M_LD_11:
    s_mov_b64 exec, s[82:83]
    s_cbranch_execz M_LD_20
    buffer_load_dwordx4 v[56:59], v38, s[24:27], 0 offen
M_LD_20:
    s_mov_b64 exec, s[86:87]
    s_cbranch_execz M_LD_21
    buffer_load_dwordx4 v[60:63], v38, s[24:27], 0 offen offset:128
M_LD_21:
    s_mov_b64 exec, s[90:91]
    s_cbranch_execz M_LD_30
    buffer_load_dwordx4 v[64:67], v39, s[24:27], 0 offen
M_LD_30:
    s_mov_b64 exec, s[94:95]
    s_cbranch_execz M_LD_31
    buffer_load_dwordx4 v[68:71], v39, s[24:27], 0 offen offset:128
M_LD_31:
    s_mov_b64 exec, -1
    s_cmp_eq_u32 s29, 0
    s_cbranch_scc0 M_NOSETUP
    s_add_u32 s39, s28, 0
    s_sub_u32 s38, s39, 0
    s_lshr_b32 s47, s38, 2
    s_lshl_b32 s47, s47, 13
    s_and_b32 s38, s38, 3
    s_lshl_b32 s38, s38, 10
    s_add_u32 s38, s38, s47
    s_add_u32 m0, s38, 4096
    s_lshl_b32 s39, s39, 10
    s_add_u32 s39, s39, 6668288
    buffer_load_dwordx4 v164, s[24:27], s39 offen lds
    s_add_u32 s39, s28, 8
    s_sub_u32 s38, s39, 0
    s_lshr_b32 s47, s38, 2
    s_lshl_b32 s47, s47, 13
    s_and_b32 s38, s38, 3
    s_lshl_b32 s38, s38, 10
    s_add_u32 s38, s38, s47
    s_add_u32 m0, s38, 4096
    s_lshl_b32 s39, s39, 10
    s_add_u32 s39, s39, 6668288
    buffer_load_dwordx4 v164, s[24:27], s39 offen lds
    s_add_u32 s39, s28, 16
    s_lshl_b32 s38, s39, 10
    s_add_u32 m0, s38, 82048
    s_lshl_b32 s39, s39, 10
    s_add_u32 s39, s39, 6668288
    buffer_load_dwordx4 v164, s[24:27], s39 offen lds
    s_add_u32 s39, s28, 24
    s_lshl_b32 s38, s39, 10
    s_add_u32 m0, s38, 126592
    s_lshl_b32 s39, s39, 10
    s_add_u32 s39, s39, 6668288
    buffer_load_dwordx4 v164, s[24:27], s39 offen lds
    s_add_u32 s39, s28, 32
    s_cmp_ge_u32 s39, 34
    s_cbranch_scc1 M_WL_SKIP
    s_sub_u32 s38, s39, 8
    s_lshr_b32 s47, s38, 2
    s_lshl_b32 s47, s47, 13
    s_and_b32 s38, s38, 3
    s_lshl_b32 s38, s38, 10
    s_add_u32 s38, s38, s47
    s_add_u32 m0, s38, 4096
    s_lshl_b32 s39, s39, 10
    s_add_u32 s39, s39, 6668288
    buffer_load_dwordx4 v164, s[24:27], s39 offen lds
M_WL_SKIP:
    v_and_b32 v2, 2, v165
    v_lshlrev_b32 v2, 3, v2
    v_and_b32 v3, 1, v165
    v_lshl_add_u32 v2, v3, 3, v2
    v_lshrrev_b32 v3, 2, v165
    v_lshl_add_u32 v2, v3, 2, v2
    v_lshlrev_b32 v2, 7, v2
    v_add_u32 v3, v2, v14
    v_add_u32 v4, v2, v15
    v_add_u32 v5, v2, v1
    v_add_u32 v6, v2, v31
    s_add_u32 s38, s46, 0
    s_mov_b32 m0, s36
    s_nop 0
    buffer_load_dwordx4 v3, s[12:15], s38 offen lds
    s_add_u32 s38, s46, 128
    s_add_u32 m0, s36, 1024
    s_nop 0
    buffer_load_dwordx4 v4, s[12:15], s38 offen lds
    s_add_u32 s38, s46, 256
    s_add_u32 m0, s36, 2048
    s_nop 0
    buffer_load_dwordx4 v5, s[12:15], s38 offen lds
    s_add_u32 s38, s46, 384
    s_add_u32 m0, s36, 3072
    s_nop 0
    buffer_load_dwordx4 v6, s[12:15], s38 offen lds
    s_mov_b32 s16, s6
    s_and_b32 s17, s7, 0xffff
    s_mov_b32 s18, 25600000
    s_mov_b32 s19, 0x00020000
    s_mov_b32 s20, s8
    s_and_b32 s21, s9, 0xffff
    s_mov_b32 s22, 6400000
    s_mov_b32 s23, 0x00020000
    v_and_b32 v162, 31, v160
    v_lshrrev_b32 v163, 5, v160
    v_xor_b32 v4, v160, v161
    v_and_b32 v4, 1, v4
    v_lshlrev_b32 v16, 4, v4
    v_lshlrev_b32 v9, 5, v163
    v_add_u32 v9, 149120, v9
    s_mov_b32 s31, 128
    s_mov_b32 s59, 0xffffffe0
    s_mov_b32 s62, 0xbfb8aa3b
    s_mov_b32 s63, 0xbfb8aa3b
    s_mov_b32 s64, 1.0
    s_mov_b32 s65, 1.0
    s_lshl_b32 s37, s28, 11
    s_add_u32 s37, s37, 65536
    s_mov_b32 s52, 81920
    s_mov_b32 s53, 98432
    s_mov_b32 s54, 114944
    v_and_b32 v2, 3, v162
    v_lshrrev_b32 v3, 4, v162
    v_and_b32 v4, 4, v162
    v_lshl_add_u32 v4, v2, 3, v4
    v_lshl_add_u32 v4, v3, 1, v4
    v_bfe_u32 v5, v162, 3, 1
    v_add_u32 v4, v4, v5
    v_lshl_add_u32 v2, v3, 2, v2
    v_xor_b32 v2, v2, v163
    v_lshlrev_b32 v2, 4, v2
    v_lshl_add_u32 v2, v4, 7, v2
    v_add_u32 v17, s36, v2
    v_xor_b32 v18, 32, v17
    v_xor_b32 v19, 64, v17
    v_xor_b32 v20, 96, v17
    v_xor_b32 v2, v5, v163
    v_lshlrev_b32 v2, 4, v2
    v_lshl_add_u32 v2, v162, 5, v2
    v_add_u32 v21, s37, v2
    v_lshrrev_b32 v2, 4, v0
    v_and_b32 v3, 6, v0
    v_lshlrev_b32 v3, 2, v3
    v_bfe_u32 v4, v0, 3, 1
    v_lshl_add_u32 v3, v4, 2, v3
    v_and_b32 v4, 1, v0
    v_lshl_add_u32 v3, v4, 1, v3
    v_mov_b32 v5, 0x3f80
    v_mov_b32 v6, 0x3f800000
    v_cmp_eq_u32 vcc, v2, v3
    s_nop 1
    v_cndmask_b32 v5, 0, v5, vcc
    v_add_u32 v3, 1, v3
    v_cmp_eq_u32 vcc, v2, v3
    s_nop 1
    v_cndmask_b32 v6, 0, v6, vcc
    v_or_b32 v5, v5, v6
    v_cmp_eq_u32 vcc, 31, v2
    v_mov_b32 v6, 0
    s_nop 0
    v_cndmask_b32 v5, v5, v6, vcc
    v_lshlrev_b32 v7, 2, v0
    v_add_u32 v8, 149120, v7
    ds_write_b32 v8, v5
    v_add_u32 v7, 147968, v7
    v_cmp_gt_u32 vcc, 288, v0
    s_and_saveexec_b64 s[42:43], vcc
    ds_write_b32 v7, v6
    s_mov_b64 exec, s[42:43]
M_NOSETUP:
    v_mov_b32 v8, 1
    s_mov_b32 s38, 147968
    s_mov_b32 s47, 4128
    s_lshr_b32 s3, s2, 5
    s_lshl_b32 s3, s3, 1
    v_and_b32 v7, 15, v0
    v_lshl_add_u32 v7, v7, 2, s38
    s_cmp_eq_u32 s29, 0
    s_cbranch_scc1 M_RW8
    s_waitcnt vmcnt(0)
M_RW8:
    s_waitcnt vmcnt(8) lgkmcnt(0)
    s_barrier
    s_mov_b64 exec, s[66:67]
    s_cbranch_execz M_AT_0
    v_bfe_u32 v2, v40, 16, 3
    v_lshrrev_b32 v3, 12, v40
    v_add_u32 v3, s3, v3
    v_and_b32 v3, 15, v3
    v_lshl_add_u32 v2, v2, 4, v3
    v_lshl_add_u32 v88, v2, 2, s38
    ds_add_rtn_u32 v72, v88, v8
M_AT_0:
    s_mov_b64 exec, s[68:69]
    s_cbranch_execz M_AT_1
    v_bfe_u32 v2, v42, 16, 3
    v_lshrrev_b32 v3, 12, v42
    v_add_u32 v3, s3, v3
    v_and_b32 v3, 15, v3
    v_lshl_add_u32 v2, v2, 4, v3
    v_lshl_add_u32 v89, v2, 2, s38
    ds_add_rtn_u32 v73, v89, v8
M_AT_1:
    s_mov_b64 exec, s[70:71]
    s_cbranch_execz M_AT_2
    v_bfe_u32 v2, v44, 16, 3
    v_lshrrev_b32 v3, 12, v44
    v_add_u32 v3, s3, v3
    v_and_b32 v3, 15, v3
    v_lshl_add_u32 v2, v2, 4, v3
    v_lshl_add_u32 v90, v2, 2, s38
    ds_add_rtn_u32 v74, v90, v8
M_AT_2:
    s_mov_b64 exec, s[72:73]
    s_cbranch_execz M_AT_3
    v_bfe_u32 v2, v46, 16, 3
    v_lshrrev_b32 v3, 12, v46
    v_add_u32 v3, s3, v3
    v_and_b32 v3, 15, v3
    v_lshl_add_u32 v2, v2, 4, v3
    v_lshl_add_u32 v91, v2, 2, s38
    ds_add_rtn_u32 v75, v91, v8
M_AT_3:
    s_mov_b64 exec, s[74:75]
    s_cbranch_execz M_AT_4
    v_bfe_u32 v2, v48, 16, 3
    v_lshrrev_b32 v3, 12, v48
    v_add_u32 v3, s3, v3
    v_and_b32 v3, 15, v3
    v_lshl_add_u32 v2, v2, 4, v3
    v_lshl_add_u32 v92, v2, 2, s38
    ds_add_rtn_u32 v76, v92, v8
M_AT_4:
    s_mov_b64 exec, s[76:77]
    s_cbranch_execz M_AT_5
    v_bfe_u32 v2, v50, 16, 3
    v_lshrrev_b32 v3, 12, v50
    v_add_u32 v3, s3, v3
    v_and_b32 v3, 15, v3
    v_lshl_add_u32 v2, v2, 4, v3
    v_lshl_add_u32 v93, v2, 2, s38
    ds_add_rtn_u32 v77, v93, v8
M_AT_5:
    s_mov_b64 exec, s[78:79]
    s_cbranch_execz M_AT_6
    v_bfe_u32 v2, v52, 16, 3
    v_lshrrev_b32 v3, 12, v52
    v_add_u32 v3, s3, v3
    v_and_b32 v3, 15, v3
    v_lshl_add_u32 v2, v2, 4, v3
    v_lshl_add_u32 v94, v2, 2, s38
    ds_add_rtn_u32 v78, v94, v8
M_AT_6:
    s_mov_b64 exec, s[80:81]
    s_cbranch_execz M_AT_7
    v_bfe_u32 v2, v54, 16, 3
    v_lshrrev_b32 v3, 12, v54
    v_add_u32 v3, s3, v3
    v_and_b32 v3, 15, v3
    v_lshl_add_u32 v2, v2, 4, v3
    v_lshl_add_u32 v95, v2, 2, s38
    ds_add_rtn_u32 v79, v95, v8
M_AT_7:
    s_mov_b64 exec, s[82:83]
    s_cbranch_execz M_AT_8
    v_bfe_u32 v2, v56, 16, 3
    v_lshrrev_b32 v3, 12, v56
    v_add_u32 v3, s3, v3
    v_and_b32 v3, 15, v3
    v_lshl_add_u32 v2, v2, 4, v3
    v_lshl_add_u32 v96, v2, 2, s38
    ds_add_rtn_u32 v80, v96, v8
M_AT_8:
    s_mov_b64 exec, s[84:85]
    s_cbranch_execz M_AT_9
    v_bfe_u32 v2, v58, 16, 3
    v_lshrrev_b32 v3, 12, v58
    v_add_u32 v3, s3, v3
    v_and_b32 v3, 15, v3
    v_lshl_add_u32 v2, v2, 4, v3
    v_lshl_add_u32 v97, v2, 2, s38
    ds_add_rtn_u32 v81, v97, v8
M_AT_9:
    s_mov_b64 exec, s[86:87]
    s_cbranch_execz M_AT_10
    v_bfe_u32 v2, v60, 16, 3
    v_lshrrev_b32 v3, 12, v60
    v_add_u32 v3, s3, v3
    v_and_b32 v3, 15, v3
    v_lshl_add_u32 v2, v2, 4, v3
    v_lshl_add_u32 v98, v2, 2, s38
    ds_add_rtn_u32 v82, v98, v8
M_AT_10:
    s_mov_b64 exec, s[88:89]
    s_cbranch_execz M_AT_11
    v_bfe_u32 v2, v62, 16, 3
    v_lshrrev_b32 v3, 12, v62
    v_add_u32 v3, s3, v3
    v_and_b32 v3, 15, v3
    v_lshl_add_u32 v2, v2, 4, v3
    v_lshl_add_u32 v99, v2, 2, s38
    ds_add_rtn_u32 v83, v99, v8
M_AT_11:
    s_mov_b64 exec, s[90:91]
    s_cbranch_execz M_AT_12
    v_bfe_u32 v2, v64, 16, 3
    v_lshrrev_b32 v3, 12, v64
    v_add_u32 v3, s3, v3
    v_and_b32 v3, 15, v3
    v_lshl_add_u32 v2, v2, 4, v3
    v_lshl_add_u32 v100, v2, 2, s38
    ds_add_rtn_u32 v84, v100, v8
M_AT_12:
    s_mov_b64 exec, s[92:93]
    s_cbranch_execz M_AT_13
    v_bfe_u32 v2, v66, 16, 3
    v_lshrrev_b32 v3, 12, v66
    v_add_u32 v3, s3, v3
    v_and_b32 v3, 15, v3
    v_lshl_add_u32 v2, v2, 4, v3
    v_lshl_add_u32 v101, v2, 2, s38
    ds_add_rtn_u32 v85, v101, v8
M_AT_13:
    s_mov_b64 exec, s[94:95]
    s_cbranch_execz M_AT_14
    v_bfe_u32 v2, v68, 16, 3
    v_lshrrev_b32 v3, 12, v68
    v_add_u32 v3, s3, v3
    v_and_b32 v3, 15, v3
    v_lshl_add_u32 v2, v2, 4, v3
    v_lshl_add_u32 v102, v2, 2, s38
    ds_add_rtn_u32 v86, v102, v8
M_AT_14:
    s_mov_b64 exec, s[96:97]
    s_cbranch_execz M_AT_15
    v_bfe_u32 v2, v70, 16, 3
    v_lshrrev_b32 v3, 12, v70
    v_add_u32 v3, s3, v3
    v_and_b32 v3, 15, v3
    v_lshl_add_u32 v2, v2, 4, v3
    v_lshl_add_u32 v103, v2, 2, s38
    ds_add_rtn_u32 v87, v103, v8
M_AT_15:
    s_mov_b64 exec, s[40:41]
    s_cbranch_execz M_AT_DONE
    v_mov_b32 v2, 149056
    ds_write_b32 v2, v8
M_AT_DONE:
    s_mov_b64 exec, -1
    s_waitcnt vmcnt(0) lgkmcnt(0)
    s_barrier
    s_cmp_eq_u32 s29, 0
    s_cbranch_scc0 M_NOWR
    v_and_b32 v2, 63, v0
    v_lshlrev_b32 v2, 4, v2
    ds_read_b128 v[112:115], v2 offset:4096
    ds_read_b128 v[116:119], v2 offset:5120
    ds_read_b128 v[120:123], v2 offset:6144
    ds_read_b128 v[124:127], v2 offset:7168
    ds_read_b128 v[128:131], v2 offset:12288
    ds_read_b128 v[132:135], v2 offset:13312
    ds_read_b128 v[136:139], v2 offset:14336
    ds_read_b128 v[140:143], v2 offset:15360
    ds_read_b128 v[168:171], v2 offset:20480
    ds_read_b128 v[172:175], v2 offset:21504
    ds_read_b128 v[176:179], v2 offset:22528
    ds_read_b128 v[180:183], v2 offset:23552
    ds_read_b128 v[184:187], v2 offset:28672
    ds_read_b128 v[188:191], v2 offset:29696
    ds_read_b128 v[192:195], v2 offset:30720
    ds_read_b128 v[196:199], v2 offset:31744
    ds_read_b128 v[232:235], v2 offset:53248
    ds_read_b128 v[236:239], v2 offset:54272
M_NOWR:
    v_and_b32 v2, 63, v0
    v_lshl_add_u32 v2, v2, 2, s38
    ds_read_b32 v3, v2
    ds_read_b32 v4, v2 offset:256
    v_mov_b32 v7, 149056
    ds_read_b32 v7, v7
    v_bfe_u32 v8, v0, 4, 2
    v_mul_u32_u24 v8, 1032, v8
    s_waitcnt lgkmcnt(0)
    v_readfirstlane_b32 s30, v7
    v_mov_b32 v5, v3
    v_mov_b32 v6, v4
    s_nop 0
    v_add_u32_dpp v5, v5, v5 row_shr:1 row_mask:0xf bank_mask:0xf bound_ctrl:0
    v_add_u32_dpp v6, v6, v6 row_shr:1 row_mask:0xf bank_mask:0xf bound_ctrl:0
    s_nop 0
    v_add_u32_dpp v5, v5, v5 row_shr:2 row_mask:0xf bank_mask:0xf bound_ctrl:0
    v_add_u32_dpp v6, v6, v6 row_shr:2 row_mask:0xf bank_mask:0xf bound_ctrl:0
    s_nop 0
    v_add_u32_dpp v5, v5, v5 row_shr:4 row_mask:0xf bank_mask:0xf bound_ctrl:0
    v_add_u32_dpp v6, v6, v6 row_shr:4 row_mask:0xf bank_mask:0xf bound_ctrl:0
    s_nop 0
    v_add_u32_dpp v5, v5, v5 row_shr:8 row_mask:0xf bank_mask:0xf bound_ctrl:0
    v_add_u32_dpp v6, v6, v6 row_shr:8 row_mask:0xf bank_mask:0xf bound_ctrl:0
    v_max_u32 v7, v5, v6
    v_cmp_lt_u32 vcc, 1000, v7
    s_cbranch_vccnz M_OVERFLOW
    v_sub_u32 v3, v5, v3
    v_sub_u32 v4, v6, v4
    v_add_u32 v3, v3, v8
    v_add3_u32 v4, v4, v8, s47
    ds_write_b32 v2, v3 offset:512
    ds_write_b32 v2, v4 offset:768
    s_and_b32 s55, s29, 0x7fffffff
    s_cmp_eq_u32 s55, 0
    s_cbranch_scc0 M_NOASSIGN
    s_mov_b32 s48, s28
    v_and_b32 v7, 15, v0
    v_cmp_eq_u32 vcc, 15, v7
    v_bfe_u32 v7, v0, 4, 2
    v_lshlrev_b32 v7, 2, v7
    v_add_u32 v7, 149072, v7
    s_mov_b64 exec, vcc
    ds_write_b32 v7, v5
    ds_write_b32 v7, v6 offset:16
    s_mov_b64 exec, -1
    v_and_b32 v7, 7, v0
    v_lshlrev_b32 v8, 2, v7
    v_add_u32 v8, 149072, v8
    s_waitcnt lgkmcnt(0)
    ds_read_b32 v8, v8
    s_waitcnt lgkmcnt(0)
    v_lshl_or_b32 v8, v8, 3, v7
    v_mov_b32 v7, 0
    v_readlane_b32 s55, v8, 0
    s_nop 1
    v_cmp_gt_u32 vcc, s55, v8
    s_nop 1
    v_addc_co_u32 v7, vcc, 0, v7, vcc
    v_readlane_b32 s55, v8, 1
    s_nop 1
    v_cmp_gt_u32 vcc, s55, v8
    s_nop 1
    v_addc_co_u32 v7, vcc, 0, v7, vcc
    v_readlane_b32 s55, v8, 2
    s_nop 1
    v_cmp_gt_u32 vcc, s55, v8
    s_nop 1
    v_addc_co_u32 v7, vcc, 0, v7, vcc
    v_readlane_b32 s55, v8, 3
    s_nop 1
    v_cmp_gt_u32 vcc, s55, v8
    s_nop 1
    v_addc_co_u32 v7, vcc, 0, v7, vcc
    v_readlane_b32 s55, v8, 4
    s_nop 1
    v_cmp_gt_u32 vcc, s55, v8
    s_nop 1
    v_addc_co_u32 v7, vcc, 0, v7, vcc
    v_readlane_b32 s55, v8, 5
    s_nop 1
    v_cmp_gt_u32 vcc, s55, v8
    s_nop 1
    v_addc_co_u32 v7, vcc, 0, v7, vcc
    v_readlane_b32 s55, v8, 6
    s_nop 1
    v_cmp_gt_u32 vcc, s55, v8
    s_nop 1
    v_addc_co_u32 v7, vcc, 0, v7, vcc
    v_readlane_b32 s55, v8, 7
    s_nop 1
    v_cmp_gt_u32 vcc, s55, v8
    s_nop 1
    v_addc_co_u32 v7, vcc, 0, v7, vcc
    s_sub_u32 s55, 11, s28
    s_cmp_lt_u32 s28, 4
    s_cselect_b32 s55, s28, s55
    v_cmp_eq_u32 vcc, s55, v7
    s_ff1_i32_b64 s48, vcc
    s_mul_i32 s42, s2, 196
    s_mul_i32 s43, s48, 49
    s_lshr_b32 s43, s43, 1
    s_add_u32 s42, s42, s43
    s_lshl_b32 s46, s42, 7
    s_sub_u32 s55, s48, s28
    s_lshl_b32 s55, s55, 13
    v_add_u32 v7, s55, v17
    ds_read_b128 v[144:147], v7
    v_add_u32 v7, s55, v18
    ds_read_b128 v[148:151], v7
    v_add_u32 v7, s55, v19
    ds_read_b128 v[152:155], v7
    v_add_u32 v7, s55, v20
    ds_read_b128 v[156:159], v7
M_NOASSIGN:
    s_and_b32 s55, s48, 3
    s_lshl_b32 s55, s55, 4
    s_add_u32 s55, s55, 15
    v_readlane_b32 s51, v5, s55
    v_readlane_b32 s56, v6, s55
    s_cmp_ge_u32 s48, 4
    s_cselect_b32 s51, s56, s51
    s_add_u32 s50, s51, 31
    s_and_b32 s50, s50, 0xffffffe0
    s_mul_i32 s49, s48, 1032
    s_waitcnt lgkmcnt(0)
    s_mov_b64 exec, s[66:67]
    s_cbranch_execz M_BS_0
    ds_read_b32 v88, v88 offset:512
M_BS_0:
    s_mov_b64 exec, s[68:69]
    s_cbranch_execz M_BS_1
    ds_read_b32 v89, v89 offset:512
M_BS_1:
    s_mov_b64 exec, s[70:71]
    s_cbranch_execz M_BS_2
    ds_read_b32 v90, v90 offset:512
M_BS_2:
    s_mov_b64 exec, s[72:73]
    s_cbranch_execz M_BS_3
    ds_read_b32 v91, v91 offset:512
M_BS_3:
    s_mov_b64 exec, s[74:75]
    s_cbranch_execz M_BS_4
    ds_read_b32 v92, v92 offset:512
M_BS_4:
    s_mov_b64 exec, s[76:77]
    s_cbranch_execz M_BS_5
    ds_read_b32 v93, v93 offset:512
M_BS_5:
    s_mov_b64 exec, s[78:79]
    s_cbranch_execz M_BS_6
    ds_read_b32 v94, v94 offset:512
M_BS_6:
    s_mov_b64 exec, s[80:81]
    s_cbranch_execz M_BS_7
    ds_read_b32 v95, v95 offset:512
M_BS_7:
    s_mov_b64 exec, s[82:83]
    s_cbranch_execz M_BS_8
    ds_read_b32 v96, v96 offset:512
M_BS_8:
    s_mov_b64 exec, s[84:85]
    s_cbranch_execz M_BS_9
    ds_read_b32 v97, v97 offset:512
M_BS_9:
    s_mov_b64 exec, s[86:87]
    s_cbranch_execz M_BS_10
    ds_read_b32 v98, v98 offset:512
M_BS_10:
    s_mov_b64 exec, s[88:89]
    s_cbranch_execz M_BS_11
    ds_read_b32 v99, v99 offset:512
M_BS_11:
    s_mov_b64 exec, s[90:91]
    s_cbranch_execz M_BS_12
    ds_read_b32 v100, v100 offset:512
M_BS_12:
    s_mov_b64 exec, s[92:93]
    s_cbranch_execz M_BS_13
    ds_read_b32 v101, v101 offset:512
M_BS_13:
    s_mov_b64 exec, s[94:95]
    s_cbranch_execz M_BS_14
    ds_read_b32 v102, v102 offset:512
M_BS_14:
    s_mov_b64 exec, s[96:97]
    s_cbranch_execz M_BS_15
    ds_read_b32 v103, v103 offset:512
M_BS_15:
    s_mov_b64 exec, -1
    v_and_b32 v5, 63, v0
    s_sub_u32 s55, s50, s51
    s_add_u32 s56, s49, s51
    v_cmp_gt_u32 vcc, s55, v5
    v_add_u32 v5, s56, v5
    v_mov_b32 v2, 0
    v_mov_b32 v3, 31
    s_mov_b64 exec, vcc
    v_lshl_add_u32 v6, v5, 1, s52
    ds_write_b16 v6, v2
    v_lshl_add_u32 v8, v5, 2, s54
    ds_write_b32 v8, v3
    s_mov_b64 exec, -1
    s_waitcnt lgkmcnt(0)
    s_mov_b64 exec, s[66:67]
    s_cbranch_execz M_PL_0
    v_add_u32 v5, v88, v72
    v_lshl_add_u32 v6, v5, 1, s52
    ds_write_b16 v6, v40
    v_lshl_add_u32 v8, v5, 2, s54
    ds_write_b32 v8, v41
M_PL_0:
    s_mov_b64 exec, s[68:69]
    s_cbranch_execz M_PL_1
    v_add_u32 v5, v89, v73
    v_lshl_add_u32 v6, v5, 1, s52
    ds_write_b16 v6, v42
    v_lshl_add_u32 v8, v5, 2, s54
    ds_write_b32 v8, v43
M_PL_1:
    s_mov_b64 exec, s[70:71]
    s_cbranch_execz M_PL_2
    v_add_u32 v5, v90, v74
    v_lshl_add_u32 v6, v5, 1, s52
    ds_write_b16 v6, v44
    v_lshl_add_u32 v8, v5, 2, s54
    ds_write_b32 v8, v45
M_PL_2:
    s_mov_b64 exec, s[72:73]
    s_cbranch_execz M_PL_3
    v_add_u32 v5, v91, v75
    v_lshl_add_u32 v6, v5, 1, s52
    ds_write_b16 v6, v46
    v_lshl_add_u32 v8, v5, 2, s54
    ds_write_b32 v8, v47
M_PL_3:
    s_mov_b64 exec, s[74:75]
    s_cbranch_execz M_PL_4
    v_add_u32 v5, v92, v76
    v_lshl_add_u32 v6, v5, 1, s52
    ds_write_b16 v6, v48
    v_lshl_add_u32 v8, v5, 2, s54
    ds_write_b32 v8, v49
M_PL_4:
    s_mov_b64 exec, s[76:77]
    s_cbranch_execz M_PL_5
    v_add_u32 v5, v93, v77
    v_lshl_add_u32 v6, v5, 1, s52
    ds_write_b16 v6, v50
    v_lshl_add_u32 v8, v5, 2, s54
    ds_write_b32 v8, v51
M_PL_5:
    s_mov_b64 exec, s[78:79]
    s_cbranch_execz M_PL_6
    v_add_u32 v5, v94, v78
    v_lshl_add_u32 v6, v5, 1, s52
    ds_write_b16 v6, v52
    v_lshl_add_u32 v8, v5, 2, s54
    ds_write_b32 v8, v53
M_PL_6:
    s_mov_b64 exec, s[80:81]
    s_cbranch_execz M_PL_7
    v_add_u32 v5, v95, v79
    v_lshl_add_u32 v6, v5, 1, s52
    ds_write_b16 v6, v54
    v_lshl_add_u32 v8, v5, 2, s54
    ds_write_b32 v8, v55
M_PL_7:
    s_mov_b64 exec, s[82:83]
    s_cbranch_execz M_PL_8
    v_add_u32 v5, v96, v80
    v_lshl_add_u32 v6, v5, 1, s52
    ds_write_b16 v6, v56
    v_lshl_add_u32 v8, v5, 2, s54
    ds_write_b32 v8, v57
M_PL_8:
    s_mov_b64 exec, s[84:85]
    s_cbranch_execz M_PL_9
    v_add_u32 v5, v97, v81
    v_lshl_add_u32 v6, v5, 1, s52
    ds_write_b16 v6, v58
    v_lshl_add_u32 v8, v5, 2, s54
    ds_write_b32 v8, v59
M_PL_9:
    s_mov_b64 exec, s[86:87]
    s_cbranch_execz M_PL_10
    v_add_u32 v5, v98, v82
    v_lshl_add_u32 v6, v5, 1, s52
    ds_write_b16 v6, v60
    v_lshl_add_u32 v8, v5, 2, s54
    ds_write_b32 v8, v61
M_PL_10:
    s_mov_b64 exec, s[88:89]
    s_cbranch_execz M_PL_11
    v_add_u32 v5, v99, v83
    v_lshl_add_u32 v6, v5, 1, s52
    ds_write_b16 v6, v62
    v_lshl_add_u32 v8, v5, 2, s54
    ds_write_b32 v8, v63
M_PL_11:
    s_mov_b64 exec, s[90:91]
    s_cbranch_execz M_PL_12
    v_add_u32 v5, v100, v84
    v_lshl_add_u32 v6, v5, 1, s52
    ds_write_b16 v6, v64
    v_lshl_add_u32 v8, v5, 2, s54
    ds_write_b32 v8, v65
M_PL_12:
    s_mov_b64 exec, s[92:93]
    s_cbranch_execz M_PL_13
    v_add_u32 v5, v101, v85
    v_lshl_add_u32 v6, v5, 1, s52
    ds_write_b16 v6, v66
    v_lshl_add_u32 v8, v5, 2, s54
    ds_write_b32 v8, v67
M_PL_13:
    s_mov_b64 exec, s[94:95]
    s_cbranch_execz M_PL_14
    v_add_u32 v5, v102, v86
    v_lshl_add_u32 v6, v5, 1, s52
    ds_write_b16 v6, v68
    v_lshl_add_u32 v8, v5, 2, s54
    ds_write_b32 v8, v69
M_PL_14:
    s_mov_b64 exec, s[96:97]
    s_cbranch_execz M_PL_15
    v_add_u32 v5, v103, v87
    v_lshl_add_u32 v6, v5, 1, s52
    ds_write_b16 v6, v70
    v_lshl_add_u32 v8, v5, 2, s54
    ds_write_b32 v8, v71
M_PL_15:
    s_mov_b64 exec, -1
    s_lshr_b32 s33, s50, 5
    s_mov_b32 s32, 0
    v_and_b32 v3, 63, v0
    s_lshl_b32 s55, s49, 1
    s_add_u32 s56, s55, s52
    v_lshrrev_b32 v2, 3, v3
    v_lshl_add_u32 v24, v2, 3, s56
    s_lshl_b32 s56, s49, 2
    s_add_u32 s56, s56, s54
    v_lshrrev_b32 v2, 1, v3
    v_and_b32 v4, 3, v2
    v_lshrrev_b32 v7, 1, v2
    v_and_or_b32 v4, v7, 12, v4
    v_lshlrev_b32 v7, 2, v2
    v_and_or_b32 v4, v7, 16, v4
    v_lshl_add_u32 v25, v4, 2, s56
    v_and_b32 v2, 31, v3
    v_and_b32 v4, 3, v2
    v_lshrrev_b32 v7, 1, v2
    v_and_or_b32 v4, v7, 12, v4
    v_lshlrev_b32 v7, 2, v2
    v_and_or_b32 v4, v7, 16, v4
    v_lshl_add_u32 v23, v4, 2, s56
    s_waitcnt lgkmcnt(0)
    s_barrier
    ds_read_b64 v[26:27], v24
    ds_read_b32 v28, v25
    ds_read_b64 v[32:33], v24 offset:64
    ds_read_b32 v34, v25 offset:128
    ds_read_b32 v29, v23
    v_and_b32 v2, 31, v0
    v_lshl_add_u32 v2, v2, 6, v9
    ds_read_b128 v[10:13], v2
    ds_read_b128 v[100:103], v2 offset:16
    s_waitcnt lgkmcnt(0)
    s_cmp_eq_u32 s33, 0
    s_cbranch_scc1 M_PRE_DONE
    v_mad_u32_u16 v2, v26, s31, v14
    v_mad_u32_u16 v3, v26, s31, v15 op_sel:[1,0,0,0]
    v_mad_u32_u16 v4, v27, s31, v1
    v_mad_u32_u16 v5, v27, s31, v31 op_sel:[1,0,0,0]
    v_and_or_b32 v6, v28, s59, v16
    s_mov_b32 m0, s36
    s_nop 0
    buffer_load_dwordx4 v2, s[12:15], 0 offen lds
    s_add_u32 m0, s36, 1024
    s_nop 0
    buffer_load_dwordx4 v3, s[12:15], 0 offen lds
    s_add_u32 m0, s36, 2048
    s_nop 0
    buffer_load_dwordx4 v4, s[12:15], 0 offen lds
    s_add_u32 m0, s36, 3072
    s_nop 0
    buffer_load_dwordx4 v5, s[12:15], 0 offen lds
    s_mov_b32 m0, s37
    s_nop 0
    buffer_load_dwordx4 v6, s[16:19], 0 offen lds
    s_cmp_eq_u32 s33, 1
    s_cbranch_scc1 M_PRE_DONE
    s_xor_b32 s36, s36, 4096
    s_xor_b32 s37, s37, 1024
    v_mad_u32_u16 v2, v32, s31, v14
    v_mad_u32_u16 v3, v32, s31, v15 op_sel:[1,0,0,0]
    v_mad_u32_u16 v4, v33, s31, v1
    v_mad_u32_u16 v5, v33, s31, v31 op_sel:[1,0,0,0]
    v_and_or_b32 v6, v34, s59, v16
    s_mov_b32 m0, s36
    s_nop 0
    buffer_load_dwordx4 v2, s[12:15], 0 offen lds
    s_add_u32 m0, s36, 1024
    s_nop 0
    buffer_load_dwordx4 v3, s[12:15], 0 offen lds
    s_add_u32 m0, s36, 2048
    s_nop 0
    buffer_load_dwordx4 v4, s[12:15], 0 offen lds
    s_add_u32 m0, s36, 3072
    s_nop 0
    buffer_load_dwordx4 v5, s[12:15], 0 offen lds
    s_mov_b32 m0, s37
    s_nop 0
    buffer_load_dwordx4 v6, s[16:19], 0 offen lds
    s_xor_b32 s36, s36, 4096
    s_xor_b32 s37, s37, 1024
M_PRE_DONE:
    v_add_u32 v24, 128, v24
    v_add_u32 v25, 256, v25
    v_add_u32 v23, 128, v23
    s_and_b32 s38, s29, 0x7fffffff
    s_cmp_eq_u32 s38, 0
    s_cbranch_scc0 M_NOAT
    v_mfma_f32_32x32x16_bf16 v[68:83], v[144:147], v[112:115], 0
    v_mfma_f32_32x32x16_bf16 v[68:83], v[148:151], v[120:123], v[68:83]
    v_mfma_f32_32x32x16_bf16 v[68:83], v[152:155], v[128:131], v[68:83]
    v_mfma_f32_32x32x16_bf16 v[68:83], v[156:159], v[136:139], v[68:83]
    v_mfma_f32_32x32x16_bf16 v[84:99], v[144:147], v[116:119], 0
    v_mfma_f32_32x32x16_bf16 v[84:99], v[148:151], v[124:127], v[84:99]
    v_mfma_f32_32x32x16_bf16 v[84:99], v[152:155], v[132:135], v[84:99]
    v_mfma_f32_32x32x16_bf16 v[84:99], v[156:159], v[140:143], v[84:99]
    s_nop 7
    v_mul_f32 v68, s62, v68
    v_mul_f32 v69, s62, v69
    v_mul_f32 v70, s62, v70
    v_mul_f32 v71, s62, v71
    v_mul_f32 v72, s62, v72
    v_mul_f32 v73, s62, v73
    v_mul_f32 v74, s62, v74
    v_mul_f32 v75, s62, v75
    v_mul_f32 v76, s62, v76
    v_mul_f32 v77, s62, v77
    v_mul_f32 v78, s62, v78
    v_mul_f32 v79, s62, v79
    v_mul_f32 v80, s62, v80
    v_mul_f32 v81, s62, v81
    v_mul_f32 v82, s62, v82
    v_mul_f32 v83, s62, v83
    v_cvt_pk_bf16_f32 v240, v68, v69
    v_cvt_pk_bf16_f32 v241, v70, v71
    v_cvt_pk_bf16_f32 v242, v72, v73
    v_cvt_pk_bf16_f32 v243, v74, v75
    v_cvt_pk_bf16_f32 v248, v76, v77
    v_cvt_pk_bf16_f32 v249, v78, v79
    v_cvt_pk_bf16_f32 v250, v80, v81
    v_cvt_pk_bf16_f32 v251, v82, v83
    v_mul_f32 v84, s62, v84
    v_mul_f32 v85, s62, v85
    v_mul_f32 v86, s62, v86
    v_mul_f32 v87, s62, v87
    v_mul_f32 v88, s62, v88
    v_mul_f32 v89, s62, v89
    v_mul_f32 v90, s62, v90
    v_mul_f32 v91, s62, v91
    v_mul_f32 v92, s62, v92
    v_mul_f32 v93, s62, v93
    v_mul_f32 v94, s62, v94
    v_mul_f32 v95, s62, v95
    v_mul_f32 v96, s62, v96
    v_mul_f32 v97, s62, v97
    v_mul_f32 v98, s62, v98
    v_mul_f32 v99, s62, v99
    v_cvt_pk_bf16_f32 v244, v84, v85
    v_cvt_pk_bf16_f32 v245, v86, v87
    v_cvt_pk_bf16_f32 v246, v88, v89
    v_cvt_pk_bf16_f32 v247, v90, v91
    v_cvt_pk_bf16_f32 v252, v92, v93
    v_cvt_pk_bf16_f32 v253, v94, v95
    v_cvt_pk_bf16_f32 v254, v96, v97
    v_cvt_pk_bf16_f32 v255, v98, v99
    v_mov_b32 v104, 0
    v_mov_b32 v105, 0
    v_mov_b32 v106, 0
    v_mov_b32 v107, 0
    v_mov_b32 v108, 0
    v_mov_b32 v109, 0
    v_mov_b32 v110, 0
    v_mov_b32 v111, 0
    v_mov_b32 v112, 0
    v_mov_b32 v113, 0
    v_mov_b32 v114, 0
    v_mov_b32 v115, 0
    v_mov_b32 v116, 0
    v_mov_b32 v117, 0
    v_mov_b32 v118, 0
    v_mov_b32 v119, 0
    v_mov_b32 v120, 0
    v_mov_b32 v121, 0
    v_mov_b32 v122, 0
    v_mov_b32 v123, 0
    v_mov_b32 v124, 0
    v_mov_b32 v125, 0
    v_mov_b32 v126, 0
    v_mov_b32 v127, 0
    v_mov_b32 v128, 0
    v_mov_b32 v129, 0
    v_mov_b32 v130, 0
    v_mov_b32 v131, 0
    v_mov_b32 v132, 0
    v_mov_b32 v133, 0
    v_mov_b32 v134, 0
    v_mov_b32 v135, 0
    v_mov_b32 v136, 0
    v_mov_b32 v137, 0
    v_mov_b32 v138, 0
    v_mov_b32 v139, 0
    v_mov_b32 v140, 0
    v_mov_b32 v141, 0
    v_mov_b32 v142, 0
    v_mov_b32 v143, 0
    v_mov_b32 v144, 0
    v_mov_b32 v145, 0
    v_mov_b32 v146, 0
    v_mov_b32 v147, 0
    v_mov_b32 v148, 0
    v_mov_b32 v149, 0
    v_mov_b32 v150, 0
    v_mov_b32 v151, 0
    v_mov_b32 v152, 0
    v_mov_b32 v153, 0
    v_mov_b32 v154, 0
    v_mov_b32 v155, 0
    v_mov_b32 v156, 0
    v_mov_b32 v157, 0
    v_mov_b32 v158, 0
    v_mov_b32 v159, 0
    v_mov_b32 v160, 0
    v_mov_b32 v161, 0
    v_mov_b32 v162, 0
    v_mov_b32 v163, 0
    v_mov_b32 v164, 0
    v_mov_b32 v165, 0
    v_mov_b32 v166, 0
    v_mov_b32 v167, 0
M_NOAT:
    s_lshl_b32 s57, s28, 2
    s_add_u32 s57, s57, 148992
    v_mov_b32 v22, s57
    s_nop 4
    s_cmp_ge_u32 s32, s33
    s_cbranch_scc1 M_LOOP_END
    s_mov_b32 s38, s32
    s_add_u32 s39, s38, 1
    s_cmp_lt_u32 s39, s33
    s_cbranch_scc1 M_W5P
    s_waitcnt vmcnt(0)
    s_branch M_W0P
M_W5P:
    s_waitcnt vmcnt(5)
M_W0P:
    v_and_b32 v2, 31, v29
    v_lshl_add_u32 v30, v2, 6, v9
    ds_read_b128 v[60:63], v30
    ds_read_b128 v[64:67], v30 offset:16
    ds_read_b128 v[40:43], v17
    ds_read_b128 v[44:47], v18
    ds_read_b128 v[48:51], v19
    ds_read_b128 v[52:55], v20
    ds_read_b128 v[56:59], v21
    ds_read_b64 v[26:27], v24
    ds_read_b32 v28, v25
    ds_read_b32 v29, v23
    s_sub_u32 s57, s33, s38
    v_mov_b32 v3, s57
    v_xor_b32 v4, 16, v22
    ds_write_b32 v22, v3
    ds_read_b32 v7, v4
    v_xor_b32 v17, 0x1000, v17
    v_xor_b32 v18, 0x1000, v18
    v_xor_b32 v19, 0x1000, v19
    v_xor_b32 v20, 0x1000, v20
    v_xor_b32 v21, 0x400, v21
    v_add_u32 v24, 64, v24
    v_add_u32 v25, 0x80, v25
    v_add_u32 v23, 0x80, v23
    v_and_b32 v8, 63, v0
    v_lshlrev_b32 v8, 4, v8
    v_add_u32 v8, 98432, v8
    ds_read_b128 v[216:219], v8
    ds_read_b128 v[220:223], v8 offset:2048
    ds_read_b128 v[224:227], v8 offset:4096
    ds_read_b128 v[228:231], v8 offset:6144
    v_mov_b32 v32, 0
    v_mov_b32 v200, 0
    v_mov_b32 v84, 0
    v_mov_b32 v33, 0
    v_mov_b32 v201, 0
    v_mov_b32 v85, 0
    v_mov_b32 v34, 0
    v_mov_b32 v202, 0
    v_mov_b32 v86, 0
    v_mov_b32 v35, 0
    v_mov_b32 v203, 0
    v_mov_b32 v87, 0
    v_mov_b32 v36, 0
    v_mov_b32 v204, 0
    v_mov_b32 v88, 0
    v_mov_b32 v37, 0
    v_mov_b32 v205, 0
    v_mov_b32 v89, 0
    v_mov_b32 v38, 0
    v_mov_b32 v206, 0
    v_mov_b32 v90, 0
    v_mov_b32 v39, 0
    v_mov_b32 v207, 0
    v_mov_b32 v91, 0
    s_waitcnt lgkmcnt(0)
    v_mfma_f32_32x32x16_bf16 v[68:83], v[40:43], v[168:171], 0
    v_mfma_f32_32x32x16_bf16 v[68:83], v[44:47], v[176:179], v[68:83]
    v_mfma_f32_32x32x16_bf16 v[68:83], v[48:51], v[184:187], v[68:83]
    v_mfma_f32_32x32x16_bf16 v[68:83], v[52:55], v[192:195], v[68:83]
    v_mfma_f32_32x32x16_bf16 v[68:83], v[56:59], v[232:235], v[68:83]
    v_mfma_f32_32x32x16_bf16 v[68:83], v[60:63], v[240:243], v[68:83]
    v_mfma_f32_32x32x16_bf16 v[68:83], v[64:67], v[248:251], v[68:83]
    s_nop 11
M_GROUP:
    v_readfirstlane_b32 s58, v7
    s_cmp_ge_u32 s57, s58
    s_cbranch_scc1 M_PHI
    s_setprio 0
    s_branch M_PDONE
M_PHI:
    s_setprio 1
M_PDONE:
    v_mfma_f32_32x32x16_bf16 v[120:135], v[32:35], v[200:203], v[120:135]
    v_exp_f32 v68, v68
    v_exp_f32 v69, v69
    v_exp_f32 v70, v70
    v_mfma_f32_32x32x16_bf16 v[120:135], v[36:39], v[204:207], v[120:135]
    v_exp_f32 v71, v71
    v_exp_f32 v72, v72
    v_exp_f32 v73, v73
    v_mfma_f32_32x32x16_bf16 v[152:167], v[32:35], v[84:87], v[152:167]
    v_exp_f32 v74, v74
    v_exp_f32 v75, v75
    v_exp_f32 v76, v76
    v_exp_f32 v77, v77
    v_mfma_f32_32x32x16_bf16 v[152:167], v[36:39], v[88:91], v[152:167]
    v_exp_f32 v78, v78
    v_exp_f32 v79, v79
    v_exp_f32 v80, v80
    v_mfma_f32_32x32x16_bf16 v[84:99], v[60:63], v[10:13], 0
    v_exp_f32 v81, v81
    v_exp_f32 v82, v82
    v_exp_f32 v83, v83
    v_mfma_f32_32x32x16_bf16 v[84:99], v[64:67], v[100:103], v[84:99]
    v_add_f32 v68, 1.0, v68
    v_add_f32 v69, 1.0, v69
    v_add_f32 v70, 1.0, v70
    v_add_f32 v71, 1.0, v71
    s_add_u32 s38, s32, 2
    s_cmp_lt_u32 s38, s33
    s_cbranch_scc0 M_NODMA
    v_mad_u32_u16 v2, v26, s31, v14
    v_mad_u32_u16 v3, v26, s31, v15 op_sel:[1,0,0,0]
    v_mad_u32_u16 v4, v27, s31, v1
    v_mad_u32_u16 v5, v27, s31, v31 op_sel:[1,0,0,0]
    v_and_or_b32 v6, v28, s59, v16
    s_mov_b32 m0, s36
    s_nop 0
    buffer_load_dwordx4 v2, s[12:15], 0 offen lds
    s_add_u32 m0, s36, 1024
    s_nop 0
    buffer_load_dwordx4 v3, s[12:15], 0 offen lds
    s_add_u32 m0, s36, 2048
    s_nop 0
    buffer_load_dwordx4 v4, s[12:15], 0 offen lds
    s_add_u32 m0, s36, 3072
    s_nop 0
    buffer_load_dwordx4 v5, s[12:15], 0 offen lds
    s_mov_b32 m0, s37
    s_nop 0
    buffer_load_dwordx4 v6, s[16:19], 0 offen lds
    s_branch M_DMAD
M_NODMA:
    s_cmp_eq_u32 s38, s33
    s_cbranch_scc0 M_DMAD
    s_cmp_eq_u32 s30, 0
    s_cbranch_scc0 M_DMAD
    v_bfe_u32 v8, v0, 3, 3
    v_and_b32 v2, 2, v8
    v_lshlrev_b32 v2, 3, v2
    v_and_b32 v3, 1, v8
    v_lshl_add_u32 v2, v3, 3, v2
    v_lshrrev_b32 v3, 2, v8
    v_lshl_add_u32 v2, v3, 2, v2
    v_lshlrev_b32 v2, 7, v2
    v_add_u32 v3, v2, v14
    v_add_u32 v4, v2, v15
    v_add_u32 v5, v2, v1
    v_add_u32 v6, v2, v31
    s_add_u32 s38, s46, 0
    s_mov_b32 m0, s36
    s_nop 0
    buffer_load_dwordx4 v3, s[12:15], s38 offen lds
    s_add_u32 s38, s46, 128
    s_add_u32 m0, s36, 1024
    s_nop 0
    buffer_load_dwordx4 v4, s[12:15], s38 offen lds
    s_add_u32 s38, s46, 256
    s_add_u32 m0, s36, 2048
    s_nop 0
    buffer_load_dwordx4 v5, s[12:15], s38 offen lds
    s_add_u32 s38, s46, 384
    s_add_u32 m0, s36, 3072
    s_nop 0
    buffer_load_dwordx4 v6, s[12:15], s38 offen lds
M_DMAD:
    s_xor_b32 s36, s36, 4096
    s_xor_b32 s37, s37, 1024
    v_add_f32 v72, 1.0, v72
    v_add_f32 v73, 1.0, v73
    v_add_f32 v74, 1.0, v74
    v_add_f32 v75, 1.0, v75
    v_add_f32 v76, 1.0, v76
    v_add_f32 v77, 1.0, v77
    v_add_f32 v78, 1.0, v78
    v_add_f32 v79, 1.0, v79
    v_add_f32 v80, 1.0, v80
    v_add_f32 v81, 1.0, v81
    v_cvt_pk_bf16_f32 v32, v84, v85
    v_cvt_pk_bf16_f32 v33, v86, v87
    v_cvt_pk_bf16_f32 v34, v88, v89
    v_cvt_pk_bf16_f32 v35, v90, v91
    v_cvt_pk_bf16_f32 v36, v92, v93
    v_cvt_pk_bf16_f32 v37, v94, v95
    v_cvt_pk_bf16_f32 v38, v96, v97
    v_cvt_pk_bf16_f32 v39, v98, v99
    v_add_f32 v82, 1.0, v82
    v_mfma_f32_32x32x16_bf16 v[84:99], v[40:43], v[216:219], 0
    v_add_f32 v83, 1.0, v83
    v_rcp_f32 v68, v68
    v_rcp_f32 v69, v69
    v_rcp_f32 v70, v70
    v_mfma_f32_32x32x16_bf16 v[84:99], v[44:47], v[220:223], v[84:99]
    v_rcp_f32 v71, v71
    v_rcp_f32 v72, v72
    v_rcp_f32 v73, v73
    v_mfma_f32_32x32x16_bf16 v[84:99], v[48:51], v[224:227], v[84:99]
    v_rcp_f32 v74, v74
    v_rcp_f32 v75, v75
    v_rcp_f32 v76, v76
    v_mfma_f32_32x32x16_bf16 v[84:99], v[52:55], v[228:231], v[84:99]
    v_rcp_f32 v77, v77
    v_rcp_f32 v78, v78
    v_and_b32 v8, 63, v0
    v_lshlrev_b32 v8, 4, v8
    v_add_u32 v8, 98432, v8
    ds_read_b128 v[216:219], v8 offset:1024
    ds_read_b128 v[220:223], v8 offset:3072
    ds_read_b128 v[224:227], v8 offset:5120
    ds_read_b128 v[228:231], v8 offset:7168
    v_rcp_f32 v79, v79
    v_rcp_f32 v80, v80
    v_mfma_f32_32x32x16_bf16 v[200:215], v[40:43], v[172:175], 0
    v_rcp_f32 v81, v81
    v_rcp_f32 v82, v82
    v_rcp_f32 v83, v83
    v_mul_f32 v84, v68, v84
    v_mfma_f32_32x32x16_bf16 v[200:215], v[44:47], v[180:183], v[200:215]
    v_mul_f32 v85, v69, v85
    v_mul_f32 v86, v70, v86
    v_mul_f32 v87, v71, v87
    v_mul_f32 v88, v72, v88
    v_mfma_f32_32x32x16_bf16 v[200:215], v[48:51], v[188:191], v[200:215]
    v_mul_f32 v89, v73, v89
    v_mul_f32 v90, v74, v90
    v_mul_f32 v91, v75, v91
    v_mul_f32 v92, v76, v92
    v_mfma_f32_32x32x16_bf16 v[200:215], v[52:55], v[196:199], v[200:215]
    v_mul_f32 v93, v77, v93
    v_mul_f32 v94, v78, v94
    v_mul_f32 v95, v79, v95
    v_mul_f32 v96, v80, v96
    v_mfma_f32_32x32x16_bf16 v[200:215], v[56:59], v[236:239], v[200:215]
    v_mul_f32 v97, v81, v97
    v_mul_f32 v98, v82, v98
    v_mul_f32 v99, v83, v99
    v_cvt_pk_bf16_f32 v68, v68, v69
    v_mfma_f32_32x32x16_bf16 v[200:215], v[60:63], v[244:247], v[200:215]
    v_cvt_pk_bf16_f32 v69, v70, v71
    v_cvt_pk_bf16_f32 v70, v72, v73
    v_cvt_pk_bf16_f32 v71, v74, v75
    v_cvt_pk_bf16_f32 v72, v76, v77
    v_cvt_pk_bf16_f32 v73, v78, v79
    v_mfma_f32_32x32x16_bf16 v[200:215], v[64:67], v[252:255], v[200:215]
    v_cvt_pk_bf16_f32 v74, v80, v81
    v_cvt_pk_bf16_f32 v75, v82, v83
    v_cvt_pk_bf16_f32 v84, v84, v85
    v_cvt_pk_bf16_f32 v85, v86, v87
    v_cvt_pk_bf16_f32 v86, v88, v89
    v_cvt_pk_bf16_f32 v87, v90, v91
    v_cvt_pk_bf16_f32 v88, v92, v93
    v_cvt_pk_bf16_f32 v89, v94, v95
    v_cvt_pk_bf16_f32 v90, v96, v97
    v_cvt_pk_bf16_f32 v91, v98, v99
    v_mfma_f32_32x32x16_bf16 v[104:119], v[32:35], v[68:71], v[104:119]
    s_nop 0
    v_exp_f32 v200, v200
    v_exp_f32 v201, v201
    v_mfma_f32_32x32x16_bf16 v[104:119], v[36:39], v[72:75], v[104:119]
    v_exp_f32 v202, v202
    v_exp_f32 v203, v203
    v_exp_f32 v204, v204
    v_mfma_f32_32x32x16_bf16 v[136:151], v[32:35], v[84:87], v[136:151]
    v_exp_f32 v205, v205
    v_exp_f32 v206, v206
    v_mfma_f32_32x32x16_bf16 v[136:151], v[36:39], v[88:91], v[136:151]
    v_exp_f32 v207, v207
    v_exp_f32 v208, v208
    v_exp_f32 v209, v209
    s_waitcnt lgkmcnt(0)
    v_mfma_f32_32x32x16_bf16 v[84:99], v[40:43], v[216:219], 0
    v_exp_f32 v210, v210
    v_exp_f32 v211, v211
    v_exp_f32 v212, v212
    v_mfma_f32_32x32x16_bf16 v[84:99], v[44:47], v[220:223], v[84:99]
    v_exp_f32 v213, v213
    v_exp_f32 v214, v214
    v_exp_f32 v215, v215
    v_mfma_f32_32x32x16_bf16 v[84:99], v[48:51], v[224:227], v[84:99]
    v_add_f32 v200, 1.0, v200
    v_add_f32 v201, 1.0, v201
    v_add_f32 v202, 1.0, v202
    v_add_f32 v203, 1.0, v203
    v_mfma_f32_32x32x16_bf16 v[84:99], v[52:55], v[228:231], v[84:99]
    v_add_f32 v204, 1.0, v204
    s_add_u32 s38, s32, 1
    s_cmp_lt_u32 s38, s33
    s_cbranch_scc0 M_NOPF
    s_add_u32 s39, s38, 1
    s_cmp_lt_u32 s39, s33
    s_cbranch_scc1 M_W5L
    s_waitcnt vmcnt(0)
    s_branch M_W0L
M_W5L:
    s_waitcnt vmcnt(5)
M_W0L:
    v_and_b32 v2, 31, v29
    v_lshl_add_u32 v30, v2, 6, v9
    ds_read_b128 v[60:63], v30
    ds_read_b128 v[64:67], v30 offset:16
    ds_read_b128 v[40:43], v17
    ds_read_b128 v[44:47], v18
    ds_read_b128 v[48:51], v19
    ds_read_b128 v[52:55], v20
    ds_read_b128 v[56:59], v21
    ds_read_b64 v[26:27], v24
    ds_read_b32 v28, v25
    ds_read_b32 v29, v23
    s_sub_u32 s57, s33, s38
    v_mov_b32 v3, s57
    v_xor_b32 v4, 16, v22
    ds_write_b32 v22, v3
    ds_read_b32 v7, v4
    v_xor_b32 v17, 0x1000, v17
    v_xor_b32 v18, 0x1000, v18
    v_xor_b32 v19, 0x1000, v19
    v_xor_b32 v20, 0x1000, v20
    v_xor_b32 v21, 0x400, v21
    v_add_u32 v24, 64, v24
    v_add_u32 v25, 0x80, v25
    v_add_u32 v23, 0x80, v23
M_NOPF:
    v_and_b32 v8, 63, v0
    v_lshlrev_b32 v8, 4, v8
    v_add_u32 v8, 98432, v8
    ds_read_b128 v[216:219], v8
    ds_read_b128 v[220:223], v8 offset:2048
    ds_read_b128 v[224:227], v8 offset:4096
    ds_read_b128 v[228:231], v8 offset:6144
    v_add_f32 v205, 1.0, v205
    v_add_f32 v206, 1.0, v206
    v_add_f32 v207, 1.0, v207
    v_add_f32 v208, 1.0, v208
    v_add_f32 v209, 1.0, v209
    v_add_f32 v210, 1.0, v210
    v_add_f32 v211, 1.0, v211
    v_add_f32 v212, 1.0, v212
    v_add_f32 v213, 1.0, v213
    v_add_f32 v214, 1.0, v214
    v_add_f32 v215, 1.0, v215
    v_rcp_f32 v200, v200
    v_rcp_f32 v201, v201
    v_rcp_f32 v202, v202
    v_rcp_f32 v203, v203
    v_rcp_f32 v204, v204
    v_rcp_f32 v205, v205
    s_waitcnt lgkmcnt(0)
    v_mfma_f32_32x32x16_bf16 v[68:83], v[40:43], v[168:171], 0
    v_rcp_f32 v206, v206
    v_rcp_f32 v207, v207
    v_rcp_f32 v208, v208
    v_rcp_f32 v209, v209
    v_mfma_f32_32x32x16_bf16 v[68:83], v[44:47], v[176:179], v[68:83]
    v_rcp_f32 v210, v210
    v_rcp_f32 v211, v211
    v_rcp_f32 v212, v212
    v_rcp_f32 v213, v213
    v_mfma_f32_32x32x16_bf16 v[68:83], v[48:51], v[184:187], v[68:83]
    v_rcp_f32 v214, v214
    v_rcp_f32 v215, v215
    v_mul_f32 v84, v200, v84
    v_mul_f32 v85, v201, v85
    v_mfma_f32_32x32x16_bf16 v[68:83], v[52:55], v[192:195], v[68:83]
    v_mul_f32 v86, v202, v86
    v_mul_f32 v87, v203, v87
    v_mul_f32 v88, v204, v88
    v_mul_f32 v89, v205, v89
    v_mul_f32 v90, v206, v90
    v_mfma_f32_32x32x16_bf16 v[68:83], v[56:59], v[232:235], v[68:83]
    v_mul_f32 v91, v207, v91
    v_mul_f32 v92, v208, v92
    v_mul_f32 v93, v209, v93
    v_mul_f32 v94, v210, v94
    v_mfma_f32_32x32x16_bf16 v[68:83], v[60:63], v[240:243], v[68:83]
    v_mul_f32 v95, v211, v95
    v_mul_f32 v96, v212, v96
    v_mul_f32 v97, v213, v97
    v_mul_f32 v98, v214, v98
    v_mfma_f32_32x32x16_bf16 v[68:83], v[64:67], v[248:251], v[68:83]
    v_mul_f32 v99, v215, v99
    v_cvt_pk_bf16_f32 v200, v200, v201
    v_cvt_pk_bf16_f32 v201, v202, v203
    v_cvt_pk_bf16_f32 v202, v204, v205
    v_cvt_pk_bf16_f32 v203, v206, v207
    v_cvt_pk_bf16_f32 v204, v208, v209
    v_cvt_pk_bf16_f32 v205, v210, v211
    v_cvt_pk_bf16_f32 v206, v212, v213
    v_cvt_pk_bf16_f32 v207, v214, v215
    v_cvt_pk_bf16_f32 v84, v84, v85
    v_cvt_pk_bf16_f32 v85, v86, v87
    v_cvt_pk_bf16_f32 v86, v88, v89
    v_cvt_pk_bf16_f32 v87, v90, v91
    v_cvt_pk_bf16_f32 v88, v92, v93
    v_cvt_pk_bf16_f32 v89, v94, v95
    v_cvt_pk_bf16_f32 v90, v96, v97
    v_cvt_pk_bf16_f32 v91, v98, v99
    s_add_u32 s32, s32, 1
    s_cmp_lt_u32 s32, s33
    s_cbranch_scc1 M_GROUP
    v_mfma_f32_32x32x16_bf16 v[120:135], v[32:35], v[200:203], v[120:135]
    v_mfma_f32_32x32x16_bf16 v[120:135], v[36:39], v[204:207], v[120:135]
    v_mfma_f32_32x32x16_bf16 v[152:167], v[32:35], v[84:87], v[152:167]
    v_mfma_f32_32x32x16_bf16 v[152:167], v[36:39], v[88:91], v[152:167]
M_LOOP_END:
    s_nop 11
    v_mov_b32 v3, 0
    ds_write_b32 v22, v3
    s_setprio 0
    s_cmp_eq_u32 s30, 0
    s_cbranch_scc1 M_EPI
    s_waitcnt vmcnt(0) lgkmcnt(0)
    s_barrier
    v_mov_b32 v6, 0
    v_lshlrev_b32 v7, 2, v0
    v_add_u32 v7, 147968, v7
    v_cmp_gt_u32 vcc, 288, v0
    s_and_saveexec_b64 s[40:41], vcc
    ds_write_b32 v7, v6
    s_mov_b64 exec, s[40:41]
    s_add_u32 s29, s29, 1
    s_add_u32 s34, s34, s35
    s_and_b32 s38, s33, 1
    s_cmp_eq_u32 s38, 0
    s_cbranch_scc1 M_PAR_OK
    v_xor_b32 v17, 0x1000, v17
    v_xor_b32 v18, 0x1000, v18
    v_xor_b32 v19, 0x1000, v19
    v_xor_b32 v20, 0x1000, v20
    v_xor_b32 v21, 0x400, v21
    s_xor_b32 s36, s36, 4096
    s_xor_b32 s37, s37, 1024
M_PAR_OK:
    s_waitcnt lgkmcnt(0)
    s_nop 1
    s_branch M_ROUND
M_OVERFLOW:
    s_waitcnt vmcnt(0) lgkmcnt(0)
    s_barrier
    v_mov_b32 v6, 0
    v_lshlrev_b32 v7, 2, v0
    v_add_u32 v7, 147968, v7
    v_cmp_gt_u32 vcc, 288, v0
    s_and_saveexec_b64 s[40:41], vcc
    ds_write_b32 v7, v6
    s_mov_b64 exec, s[40:41]
    s_mov_b32 s35, 4
    s_cmp_eq_u32 s29, 0
    s_cbranch_scc0 M_OV2
    s_mov_b32 s29, 0x80000000
M_OV2:
    s_waitcnt lgkmcnt(0)
    s_branch M_ROUND
M_EPI:
    s_cmp_ge_u32 s33, 2
    s_cbranch_scc1 M_EPI_HAVE
    v_bfe_u32 v8, v0, 3, 3
    v_and_b32 v2, 2, v8
    v_lshlrev_b32 v2, 3, v2
    v_and_b32 v3, 1, v8
    v_lshl_add_u32 v2, v3, 3, v2
    v_lshrrev_b32 v3, 2, v8
    v_lshl_add_u32 v2, v3, 2, v2
    v_lshlrev_b32 v2, 7, v2
    v_add_u32 v3, v2, v14
    v_add_u32 v4, v2, v15
    v_add_u32 v5, v2, v1
    v_add_u32 v6, v2, v31
    s_add_u32 s38, s46, 0
    s_mov_b32 m0, s36
    s_nop 0
    buffer_load_dwordx4 v3, s[12:15], s38 offen lds
    s_add_u32 s38, s46, 128
    s_add_u32 m0, s36, 1024
    s_nop 0
    buffer_load_dwordx4 v4, s[12:15], s38 offen lds
    s_add_u32 s38, s46, 256
    s_add_u32 m0, s36, 2048
    s_nop 0
    buffer_load_dwordx4 v5, s[12:15], s38 offen lds
    s_add_u32 s38, s46, 384
    s_add_u32 m0, s36, 3072
    s_nop 0
    buffer_load_dwordx4 v6, s[12:15], s38 offen lds
M_EPI_HAVE:
    v_and_b32 v2, 63, v0
    v_and_b32 v3, 31, v2
    v_lshrrev_b32 v4, 5, v2
    v_lshlrev_b32 v5, 4, v2
    v_add_u32 v6, 151168, v5
    ds_read_b128 v[40:43], v6
    ds_read_b128 v[44:47], v6 offset:1024
    ds_read_b128 v[48:51], v6 offset:2048
    ds_read_b128 v[52:55], v6 offset:3072
    ds_read_b128 v[56:59], v6 offset:4096
    ds_read_b128 v[60:63], v6 offset:5120
    ds_read_b128 v[64:67], v6 offset:6144
    ds_read_b128 v[68:71], v6 offset:7168
    v_lshrrev_b32 v6, 3, v2
    v_and_b32 v7, 3, v6
    v_and_b32 v8, 4, v6
    v_lshl_add_u32 v8, v7, 3, v8
    v_and_b32 v6, 7, v2
    v_xor_b32 v6, v6, v7
    v_lshlrev_b32 v6, 4, v6
    v_lshl_add_u32 v6, v8, 7, v6
    v_add_u32 v6, s36, v6
    v_xor_b32 v7, 64, v6
    v_add_f32 v104, 0x358637bd, v104
    v_add_f32 v105, 0x358637bd, v105
    v_add_f32 v106, 0x358637bd, v106
    v_add_f32 v107, 0x358637bd, v107
    v_add_f32 v108, 0x358637bd, v108
    v_add_f32 v109, 0x358637bd, v109
    v_add_f32 v110, 0x358637bd, v110
    v_add_f32 v111, 0x358637bd, v111
    v_add_f32 v112, 0x358637bd, v112
    v_add_f32 v113, 0x358637bd, v113
    v_add_f32 v114, 0x358637bd, v114
    v_add_f32 v115, 0x358637bd, v115
    v_add_f32 v116, 0x358637bd, v116
    v_add_f32 v117, 0x358637bd, v117
    v_add_f32 v118, 0x358637bd, v118
    v_add_f32 v119, 0x358637bd, v119
    v_add_f32 v120, 0x358637bd, v120
    v_add_f32 v121, 0x358637bd, v121
    v_add_f32 v122, 0x358637bd, v122
    v_add_f32 v123, 0x358637bd, v123
    v_add_f32 v124, 0x358637bd, v124
    v_add_f32 v125, 0x358637bd, v125
    v_add_f32 v126, 0x358637bd, v126
    v_add_f32 v127, 0x358637bd, v127
    v_add_f32 v128, 0x358637bd, v128
    v_add_f32 v129, 0x358637bd, v129
    v_add_f32 v130, 0x358637bd, v130
    v_add_f32 v131, 0x358637bd, v131
    v_add_f32 v132, 0x358637bd, v132
    v_add_f32 v133, 0x358637bd, v133
    v_add_f32 v134, 0x358637bd, v134
    v_add_f32 v135, 0x358637bd, v135
    v_rcp_f32 v104, v104
    v_rcp_f32 v105, v105
    v_rcp_f32 v106, v106
    v_rcp_f32 v107, v107
    v_rcp_f32 v108, v108
    v_rcp_f32 v109, v109
    v_rcp_f32 v110, v110
    v_rcp_f32 v111, v111
    v_rcp_f32 v112, v112
    v_rcp_f32 v113, v113
    v_rcp_f32 v114, v114
    v_rcp_f32 v115, v115
    v_rcp_f32 v116, v116
    v_rcp_f32 v117, v117
    v_rcp_f32 v118, v118
    v_rcp_f32 v119, v119
    v_rcp_f32 v120, v120
    v_rcp_f32 v121, v121
    v_rcp_f32 v122, v122
    v_rcp_f32 v123, v123
    v_rcp_f32 v124, v124
    v_rcp_f32 v125, v125
    v_rcp_f32 v126, v126
    v_rcp_f32 v127, v127
    v_rcp_f32 v128, v128
    v_rcp_f32 v129, v129
    v_rcp_f32 v130, v130
    v_rcp_f32 v131, v131
    v_rcp_f32 v132, v132
    v_rcp_f32 v133, v133
    v_rcp_f32 v134, v134
    v_rcp_f32 v135, v135
    v_mul_f32 v136, v136, v104
    v_mul_f32 v137, v137, v105
    v_mul_f32 v138, v138, v106
    v_mul_f32 v139, v139, v107
    v_mul_f32 v140, v140, v108
    v_mul_f32 v141, v141, v109
    v_mul_f32 v142, v142, v110
    v_mul_f32 v143, v143, v111
    v_mul_f32 v144, v144, v112
    v_mul_f32 v145, v145, v113
    v_mul_f32 v146, v146, v114
    v_mul_f32 v147, v147, v115
    v_mul_f32 v148, v148, v116
    v_mul_f32 v149, v149, v117
    v_mul_f32 v150, v150, v118
    v_mul_f32 v151, v151, v119
    v_mul_f32 v152, v152, v120
    v_mul_f32 v153, v153, v121
    v_mul_f32 v154, v154, v122
    v_mul_f32 v155, v155, v123
    v_mul_f32 v156, v156, v124
    v_mul_f32 v157, v157, v125
    v_mul_f32 v158, v158, v126
    v_mul_f32 v159, v159, v127
    v_mul_f32 v160, v160, v128
    v_mul_f32 v161, v161, v129
    v_mul_f32 v162, v162, v130
    v_mul_f32 v163, v163, v131
    v_mul_f32 v164, v164, v132
    v_mul_f32 v165, v165, v133
    v_mul_f32 v166, v166, v134
    v_mul_f32 v167, v167, v135
    s_waitcnt vmcnt(0)
    ds_read_b128 v[72:75], v17
    ds_read_b128 v[76:79], v18
    ds_read_b128 v[80:83], v19
    ds_read_b128 v[84:87], v20
    ds_read_b128 v[88:91], v6
    ds_read_b128 v[92:95], v6 offset:128
    ds_read_b128 v[96:99], v7 offset:256
    ds_read_b128 v[100:103], v7 offset:384
    s_waitcnt lgkmcnt(0)
    v_mfma_f32_32x32x16_bf16 v[136:151], v[72:75], v[40:43], v[136:151]
    v_mfma_f32_32x32x16_bf16 v[136:151], v[76:79], v[48:51], v[136:151]
    v_mfma_f32_32x32x16_bf16 v[136:151], v[80:83], v[56:59], v[136:151]
    v_mfma_f32_32x32x16_bf16 v[136:151], v[84:87], v[64:67], v[136:151]
    v_mfma_f32_32x32x16_bf16 v[152:167], v[72:75], v[44:47], v[152:167]
    v_mfma_f32_32x32x16_bf16 v[152:167], v[76:79], v[52:55], v[152:167]
    v_mfma_f32_32x32x16_bf16 v[152:167], v[80:83], v[60:63], v[152:167]
    v_mfma_f32_32x32x16_bf16 v[152:167], v[84:87], v[68:71], v[152:167]
    s_lshl_b32 s38, s28, 13
    v_lshlrev_b32 v6, 10, v4
    v_lshl_add_u32 v6, v3, 2, v6
    v_add_u32 v6, s38, v6
    v_lshlrev_b32 v7, 5, v2
    v_add_u32 v7, s38, v7
    s_nop 1
    v_max_f32 v136, 0, v136
    ds_write_b32 v6, v136
    v_max_f32 v137, 0, v137
    ds_write_b32 v6, v137 offset:256
    v_max_f32 v138, 0, v138
    ds_write_b32 v6, v138 offset:512
    v_max_f32 v139, 0, v139
    ds_write_b32 v6, v139 offset:768
    v_max_f32 v140, 0, v140
    ds_write_b32 v6, v140 offset:2048
    v_max_f32 v141, 0, v141
    ds_write_b32 v6, v141 offset:2304
    v_max_f32 v142, 0, v142
    ds_write_b32 v6, v142 offset:2560
    v_max_f32 v143, 0, v143
    ds_write_b32 v6, v143 offset:2816
    v_max_f32 v144, 0, v144
    ds_write_b32 v6, v144 offset:4096
    v_max_f32 v145, 0, v145
    ds_write_b32 v6, v145 offset:4352
    v_max_f32 v146, 0, v146
    ds_write_b32 v6, v146 offset:4608
    v_max_f32 v147, 0, v147
    ds_write_b32 v6, v147 offset:4864
    v_max_f32 v148, 0, v148
    ds_write_b32 v6, v148 offset:6144
    v_max_f32 v152, 0, v152
    ds_write_b32 v6, v152 offset:128
    v_max_f32 v153, 0, v153
    ds_write_b32 v6, v153 offset:384
    v_max_f32 v154, 0, v154
    ds_write_b32 v6, v154 offset:640
    v_max_f32 v155, 0, v155
    ds_write_b32 v6, v155 offset:896
    v_max_f32 v156, 0, v156
    ds_write_b32 v6, v156 offset:2176
    v_max_f32 v157, 0, v157
    ds_write_b32 v6, v157 offset:2432
    v_max_f32 v158, 0, v158
    ds_write_b32 v6, v158 offset:2688
    v_max_f32 v159, 0, v159
    ds_write_b32 v6, v159 offset:2944
    v_max_f32 v160, 0, v160
    ds_write_b32 v6, v160 offset:4224
    v_max_f32 v161, 0, v161
    ds_write_b32 v6, v161 offset:4480
    v_max_f32 v162, 0, v162
    ds_write_b32 v6, v162 offset:4736
    v_max_f32 v163, 0, v163
    ds_write_b32 v6, v163 offset:4992
    v_max_f32 v164, 0, v164
    ds_write_b32 v6, v164 offset:6272
    s_waitcnt lgkmcnt(0)
    ds_read_b128 v[104:107], v7
    ds_read_b128 v[108:111], v7 offset:16
    ds_read_b128 v[112:115], v7 offset:2048
    ds_read_b128 v[116:119], v7 offset:2064
    ds_read_b128 v[120:123], v7 offset:4096
    ds_read_b128 v[124:127], v7 offset:4112
    ds_read_b128 v[128:131], v7 offset:6144
    ds_read_b128 v[132:135], v7 offset:6160
    v_mov_b32 v8, 0x40000000
    s_and_b32 s38, s48, 1
    s_lshl_b32 s38, s38, 3
    v_cmp_gt_u32 vcc, s38, v2
    s_nop 1
    v_cndmask_b32 v8, v8, v5, vcc
    s_waitcnt vmcnt(0) lgkmcnt(0)
    v_lshlrev_b32 v2, 16, v88
    v_and_b32 v3, 0xffff0000, v88
    v_add_f32 v2, v2, v104
    v_add_f32 v3, v3, v105
    v_cvt_pk_bf16_f32 v88, v2, v3
    v_lshlrev_b32 v2, 16, v89
    v_and_b32 v3, 0xffff0000, v89
    v_add_f32 v2, v2, v106
    v_add_f32 v3, v3, v107
    v_cvt_pk_bf16_f32 v89, v2, v3
    v_lshlrev_b32 v2, 16, v90
    v_and_b32 v3, 0xffff0000, v90
    v_add_f32 v2, v2, v108
    v_add_f32 v3, v3, v109
    v_cvt_pk_bf16_f32 v90, v2, v3
    v_lshlrev_b32 v2, 16, v91
    v_and_b32 v3, 0xffff0000, v91
    v_add_f32 v2, v2, v110
    v_add_f32 v3, v3, v111
    v_cvt_pk_bf16_f32 v91, v2, v3
    buffer_store_dwordx4 v[88:91], v5, s[20:23], s46 offen
    v_lshlrev_b32 v2, 16, v92
    v_and_b32 v3, 0xffff0000, v92
    v_add_f32 v2, v2, v112
    v_add_f32 v3, v3, v113
    v_cvt_pk_bf16_f32 v92, v2, v3
    v_lshlrev_b32 v2, 16, v93
    v_and_b32 v3, 0xffff0000, v93
    v_add_f32 v2, v2, v114
    v_add_f32 v3, v3, v115
    v_cvt_pk_bf16_f32 v93, v2, v3
    v_lshlrev_b32 v2, 16, v94
    v_and_b32 v3, 0xffff0000, v94
    v_add_f32 v2, v2, v116
    v_add_f32 v3, v3, v117
    v_cvt_pk_bf16_f32 v94, v2, v3
    v_lshlrev_b32 v2, 16, v95
    v_and_b32 v3, 0xffff0000, v95
    v_add_f32 v2, v2, v118
    v_add_f32 v3, v3, v119
    v_cvt_pk_bf16_f32 v95, v2, v3
    buffer_store_dwordx4 v[92:95], v5, s[20:23], s46 offen offset:1024
    v_lshlrev_b32 v2, 16, v96
    v_and_b32 v3, 0xffff0000, v96
    v_add_f32 v2, v2, v120
    v_add_f32 v3, v3, v121
    v_cvt_pk_bf16_f32 v96, v2, v3
    v_lshlrev_b32 v2, 16, v97
    v_and_b32 v3, 0xffff0000, v97
    v_add_f32 v2, v2, v122
    v_add_f32 v3, v3, v123
    v_cvt_pk_bf16_f32 v97, v2, v3
    v_lshlrev_b32 v2, 16, v98
    v_and_b32 v3, 0xffff0000, v98
    v_add_f32 v2, v2, v124
    v_add_f32 v3, v3, v125
    v_cvt_pk_bf16_f32 v98, v2, v3
    v_lshlrev_b32 v2, 16, v99
    v_and_b32 v3, 0xffff0000, v99
    v_add_f32 v2, v2, v126
    v_add_f32 v3, v3, v127
    v_cvt_pk_bf16_f32 v99, v2, v3
    buffer_store_dwordx4 v[96:99], v5, s[20:23], s46 offen offset:2048
    v_lshlrev_b32 v2, 16, v100
    v_and_b32 v3, 0xffff0000, v100
    v_add_f32 v2, v2, v128
    v_add_f32 v3, v3, v129
    v_cvt_pk_bf16_f32 v100, v2, v3
    v_lshlrev_b32 v2, 16, v101
    v_and_b32 v3, 0xffff0000, v101
    v_add_f32 v2, v2, v130
    v_add_f32 v3, v3, v131
    v_cvt_pk_bf16_f32 v101, v2, v3
    v_lshlrev_b32 v2, 16, v102
    v_and_b32 v3, 0xffff0000, v102
    v_add_f32 v2, v2, v132
    v_add_f32 v3, v3, v133
    v_cvt_pk_bf16_f32 v102, v2, v3
    v_lshlrev_b32 v2, 16, v103
    v_and_b32 v3, 0xffff0000, v103
    v_add_f32 v2, v2, v134
    v_add_f32 v3, v3, v135
    v_cvt_pk_bf16_f32 v103, v2, v3
    buffer_store_dwordx4 v[100:103], v8, s[20:23], s46 offen offset:3072
M_END:
    s_endpgm
.section .rodata,"a"
.p2align 6
.amdhsa_kernel gp_part_kernel
  .amdhsa_next_free_vgpr 64
  .amdhsa_next_free_sgpr 64
  .amdhsa_accum_offset 64
  .amdhsa_group_segment_fixed_size 0
  .amdhsa_kernarg_size 96
  .amdhsa_user_sgpr_count 2
  .amdhsa_user_sgpr_kernarg_segment_ptr 1
  .amdhsa_system_sgpr_workgroup_id_x 1
.end_amdhsa_kernel
.p2align 6
.amdhsa_kernel gp_main_kernel
  .amdhsa_next_free_vgpr 256
  .amdhsa_next_free_sgpr 102
  .amdhsa_accum_offset 256
  .amdhsa_group_segment_fixed_size 0
  .amdhsa_kernarg_size 96
  .amdhsa_user_sgpr_count 2
  .amdhsa_user_sgpr_kernarg_segment_ptr 1
  .amdhsa_system_sgpr_workgroup_id_x 1
.end_amdhsa_kernel
```
